```python
import torch

def _softmax(x, axis=-1):
    return torch.softmax(x, dim=axis)
def _gelu(x):
    return torch.nn.functional.gelu(x, approximate="tanh")
def _silu(x):
    return torch.nn.functional.silu(x)
def _sigmoid(x):
    return torch.sigmoid(x)
def _layernorm(x, axis=-1, eps=1e-5):
    m = x.mean(dim=axis, keepdim=True)
    v = x.var(dim=axis, keepdim=True, unbiased=False)
    return (x - m) / torch.sqrt(v + eps)
def _scatter_add(tgt, idx, src, axis=0):
    return tgt.clone().index_add_(axis, idx, src)
def _segment_sum(src, seg, n):
    out = torch.zeros((n,) + src.shape[1:], dtype=src.dtype)
    return out.index_add_(0, seg, src)
def _pad(x, pw):
    flat = tuple(v for pair in reversed(pw) for v in pair)
    return torch.nn.functional.pad(x, flat)

kernel_name = 'concat_heads__linear_kernel_hedgehog__ssm_conv_s4__prompt'

def setup_inputs():

    _w = (lambda a: (lambda t: t.to(torch.bfloat16) if t.is_floating_point() else t)(torch.as_tensor(a)))
    def _A_setup():
        B, S, D, H = 1, 2048, 640, 32
        Dh = D // H
        return {
            "x": _w((lambda *s: torch.randn(*s, dtype=torch.bfloat16) * 0.4)(B, S, D)),
            "wqkv": _w((lambda *s: torch.randn(*s, dtype=torch.bfloat16) * 0.4)(D, 3 * D)),
            "w_phi": _w((lambda *s: torch.randn(*s, dtype=torch.bfloat16) * 0.4)(H, Dh, Dh) * (Dh ** -0.5)),
            "wo": _w((lambda *s: torch.randn(*s, dtype=torch.bfloat16) * 0.05)(D, D)),
        }
    _A_in = _A_setup()

    def _B_setup():
        B, L, D, N = 1, 2048, 640, 128
        A_re = -(lambda _x: torch.exp(torch.as_tensor(_x)))((lambda *s: torch.randn(*s, dtype=torch.bfloat16) * 3.2)(D, N))
        A_im = torch.pi * (lambda *s: torch.randn(*s, dtype=torch.bfloat16) * 0.2)(D, N)
        B_re = (lambda *s: torch.randn(*s, dtype=torch.bfloat16) * 0.4)(D, N)
        B_im = (lambda *s: torch.randn(*s, dtype=torch.bfloat16) * 0.4)(D, N)
        C_re = (lambda *s: torch.randn(*s, dtype=torch.bfloat16) * 0.4)(D, N)
        C_im = (lambda *s: torch.randn(*s, dtype=torch.bfloat16) * 0.4)(D, N)
        log_dt = (lambda *s: torch.randn(*s, dtype=torch.bfloat16) * 0.2)(D) * 0.5 - 4.0
        Dskip = (lambda *s: torch.randn(*s, dtype=torch.bfloat16) * 0.4)(D)
        return {
            "u": _w((lambda *s: torch.randn(*s, dtype=torch.bfloat16) * 0.05)(B, L, D)),
            "A_re": _w(A_re),
            "A_im": _w(A_im),
            "B_re": _w(B_re),
            "B_im": _w(B_im),
            "C_re": _w(C_re),
            "C_im": _w(C_im),
            "log_dt": _w(log_dt),
            "Dskip": _w(Dskip),
        }
    _B_in = _B_setup()

    return {
        "A_x": _A_in["x"],
        "A_wqkv": _A_in["wqkv"],
        "A_w_phi": _A_in["w_phi"],
        "A_wo": _A_in["wo"],
        "B_u": _B_in["u"],
        "B_A_re": _B_in["A_re"],
        "B_A_im": _B_in["A_im"],
        "B_B_re": _B_in["B_re"],
        "B_B_im": _B_in["B_im"],
        "B_C_re": _B_in["C_re"],
        "B_C_im": _B_in["C_im"],
        "B_log_dt": _B_in["log_dt"],
        "B_Dskip": _B_in["Dskip"],
    }

def reference(A_x, A_wqkv, A_w_phi, A_wo, B_u, B_A_re, B_A_im, B_B_re, B_B_im, B_C_re, B_C_im, B_log_dt, B_Dskip):
    def _A_ref(x, wqkv, w_phi, wo):
        B, S, D = x.shape
        H = 32; Dh = D // H
        qkv = (lambda x, *d: x.permute(*d))((x @ wqkv).reshape(B, S, 3, H, Dh), 2, 0, 3, 1, 4)
        q, k, v = qkv[0], qkv[1], qkv[2]
        pq = torch.einsum("bhsd,hdf->bhsf", q, w_phi)
        pk = torch.einsum("bhsd,hdf->bhsf", k, w_phi)
        phi_q = torch.concatenate([_softmax(pq, axis=-1), _softmax(-pq, axis=-1)], axis=-1)
        phi_k = torch.concatenate([_softmax(pk, axis=-1), _softmax(-pk, axis=-1)], axis=-1)
        kv = torch.einsum("bhsf,bhsd->bhfd", phi_k, v)
        z  = torch.einsum("bhsf->bhf", phi_k)
        num = torch.einsum("bhqf,bhfd->bhqd", phi_q, kv)
        den = torch.einsum("bhqf,bhf->bhq", phi_q, z)[..., None] + 1e-6
        o = num / den
        return (lambda x, *d: x.permute(*d))(o, 0, 2, 1, 3).reshape(B, S, D) @ wo

    def _B_ref(u, A_re, A_im, B_re, B_im, C_re, C_im, log_dt, Dskip):
        Bsz, L, D = u.shape
        dt = torch.exp(log_dt)[:, None]
        A = A_re + 1j * A_im
        Bc = B_re + 1j * B_im
        Cc = C_re + 1j * C_im
        logdA = dt * A
        dB = dt * Bc
        l = (lambda x, dt: x.to(dt))(torch.arange(L), A_re.dtype)
        P = torch.exp(logdA[:, :, None] * l[None, None, :])
        K = torch.einsum("dn,dnl,dn->dl", Cc, P, dB).real
        L2 = 2 * L
        Kp = _pad(K, ((0, 0), (0, L)))
        up = (lambda x, *d: x.permute(*d))(u, 0, 2, 1)
        up = _pad(up, ((0, 0), (0, 0), (0, L)))
        Kf = (lambda x, axes=(-2,-1): torch.fft.rfft2(x.float(), dim=axes))(Kp[:, None, :], axes=(-2, -1))
        Uf = (lambda x, axes=(-2,-1): torch.fft.rfft2(x.float(), dim=axes))(up[:, :, None, :], axes=(-2, -1))
        Yf = Uf * Kf[None, :, :, :]
        y = (lambda x, s, axes=(-2,-1): torch.fft.irfft2(x, s=s, dim=axes).to(torch.bfloat16))(Yf, (1, L2), axes=(-2, -1))[:, :, 0, :L]
        y = (lambda x, *d: x.permute(*d))(y, 0, 2, 1) + u * Dskip[None, None, :]
        return y

    a = _A_ref(A_x, A_wqkv, A_w_phi, A_wo)
    b = _B_ref(B_u, B_A_re, B_A_im, B_B_re, B_B_im, B_C_re, B_C_im, B_log_dt, B_Dskip)
    return torch.concatenate([a, b], axis=-1)
```

```asm
; @launch grid=(256,1,1) block=(512,1,1) lds=163840
.amdgcn_target "amdgcn-amd-amdhsa--gfx950"
.text
.globl concat_heads__linear_kernel_hedgehog__ssm_conv_s4__prompt_kernel
.p2align 8
.type concat_heads__linear_kernel_hedgehog__ssm_conv_s4__prompt_kernel,@function
concat_heads__linear_kernel_hedgehog__ssm_conv_s4__prompt_kernel:
    s_getpc_b64 s[8:9]
m_codestart:
    s_load_dwordx16 s[16:31], s[0:1], 0
    s_load_dwordx16 s[32:47], s[0:1], 64
    s_cmp_lt_u32 s2, 192
    s_cbranch_scc1 m_nopf
    v_lshlrev_b32 v15, 7, v0
    v_min_u32 v15, m_codeend-m_codestart-8, v15
    global_load_dword v15, v15, s[8:9]
m_nopf:
    s_cmp_ge_u32 s2, 256
    s_cbranch_scc1 m_exit
    v_and_b32 v1, 63, v0
    v_lshrrev_b32 v2, 6, v0
    s_nop 0
    v_readfirstlane_b32 s3, v2
    v_and_b32 v3, 15, v1
    v_lshrrev_b32 v4, 4, v1
    v_bfe_u32 v5, v1, 2, 2
    v_and_b32 v6, 3, v1
    v_lshlrev_b32 v7, 4, v1
    s_and_b32 s4, s2, 7
    s_lshr_b32 s5, s2, 3
    s_lshr_b32 s69, s3, 2
    s_and_b32 s70, s3, 3
    s_lshr_b32 s7, s5, 2
    s_mov_b32 s66, 1069066811
    s_mov_b32 s67, 1069066811
    s_mov_b32 s68, 0
    s_mov_b32 s11, -1
    s_mov_b32 s72, -1
    v_mov_b32 v12, 1
    v_mov_b32 v13, 0
    v_mov_b32 v253, 0
    v_mov_b32 v11, 0
    v_mov_b32 v14, 0
    v_mov_b32 v16, 0
    v_mov_b32 v252, 0
    s_lshl_b32 s64, s2, 1
    s_sub_u32 s64, s64, 192
    s_cmp_lt_u32 s2, 192
    s_cselect_b32 s64, s2, s64
    s_lshr_b32 s6, s4, 1
    s_lshl_b32 s6, s6, 2
    s_and_b32 s12, s5, 3
    s_add_u32 s6, s6, s12
    s_and_b32 s12, s4, 1
    s_lshl_b32 s12, s12, 4
    s_lshl_b32 s8, s7, 2
    s_lshl_b32 s13, s7, 3
    s_sub_u32 s13, s13, 32
    s_cmp_lt_u32 s7, 4
    s_cselect_b32 s8, s8, s13
    s_add_u32 s8, s8, s12
    s_sub_u32 s12, s2, 192
    s_cmp_ge_u32 s7, 6
    s_cselect_b32 s6, s12, s6
    v_and_b32 v255, 7, v1
    v_lshlrev_b32 v255, 2, v255
    s_mov_b32 s55, 0
    s_mov_b32 s74, 0
    s_cmp_lg_u32 s69, 0
    s_cbranch_scc1 m_hi
m_lo:
    v_add_u32 v8, 163808, v255
    ds_write_b32 v8, v13
    v_lshlrev_b32 v19, 1, v0
    s_waitcnt lgkmcnt(0)
    s_lshl_b32 s12, s64, 9
    s_lshl_b32 s13, s64, 2
    s_load_dword s65, s[38:39], s13
    v_add_u32 v8, s12, v19
    global_load_ushort v138, v8, s[26:27]
    global_load_ushort v139, v8, s[28:29]
    global_load_ushort v140, v8, s[30:31]
    global_load_ushort v141, v8, s[32:33]
    global_load_ushort v142, v8, s[34:35]
    global_load_ushort v143, v8, s[36:37]
    s_lshl_b32 s12, s64, 2
    s_load_dwordx2 s[40:41], s[40:41], s12
    s_add_u32 s56, s46, 21037056
    s_addc_u32 s57, s47, 0
    s_mov_b32 s58, 65536
    s_mov_b32 s59, 0x20000
    s_mov_b32 s60, s44
    s_mov_b32 s61, s45
    s_mov_b32 s62, 256
    s_mov_b32 s63, 0x20000
    s_cmp_lt_u32 s2, 248
    s_cbranch_scc1 m_tab0
    s_cmp_lg_u32 s3, 0
    s_cbranch_scc1 m_tab0
    s_lshl_b32 s12, s4, 13
    s_add_u32 s13, s12, 4096
    v_mov_b32 v144, 0
    v_mov_b32 v145, 0
    v_mov_b32 v146, 0
    v_mov_b32 v147, 0
    buffer_store_dwordx4 v[144:147], v7, s[56:59], s12 offen offset:0 sc1
    buffer_store_dwordx4 v[144:147], v7, s[56:59], s12 offen offset:1024 sc1
    buffer_store_dwordx4 v[144:147], v7, s[56:59], s12 offen offset:2048 sc1
    buffer_store_dwordx4 v[144:147], v7, s[56:59], s12 offen offset:3072 sc1
    buffer_store_dwordx4 v[144:147], v7, s[56:59], s13 offen offset:0 sc1
    buffer_store_dwordx4 v[144:147], v7, s[56:59], s13 offen offset:1024 sc1
    buffer_store_dwordx4 v[144:147], v7, s[56:59], s13 offen offset:2048 sc1
    buffer_store_dwordx4 v[144:147], v7, s[56:59], s13 offen offset:3072 sc1
    s_mov_b32 s11, s4
    s_waitcnt vmcnt(0)
    s_lshl_b32 s11, s11, 2
    s_mov_b64 exec, 1
    buffer_store_dword v12, v13, s[60:63], s11 offen sc1
    s_mov_b64 exec, -1
    s_mov_b32 s11, -1
m_tab0:
    s_lshr_b32 s14, s70, 1
    s_mul_i32 s15, s14, 34304
    s_add_u32 s15, s15, 73728
    v_lshlrev_b32 v10, 4, v4
    v_add_u32 v10, s15, v10
    s_and_b32 s13, s70, 1
    s_mov_b32 s14, 544
    v_mad_u32_u24 v136, v3, s14, v10
    v_sub_u32 v8, 15, v3
    v_cvt_f32_u32 v9, v8
    s_mov_b32 s12, 504958976
    s_cmp_lg_u32 s13, 0
    s_cselect_b32 s12, 740894243, s12
    s_cmp_lg_u32 s13, 0
    s_cselect_b32 s15, -3, 0
    v_ldexp_f32 v8, v9, s15
    v_rndne_f32 v8, v8
    v_cvt_u32_f32 v8, v8
    s_bfe_u32 s15, s12, 524288
    v_add_u32 v8, s15, v8
    v_mad_u32_u24 v132, v8, s14, v10
    s_cmp_lg_u32 s13, 0
    s_cselect_b32 s15, -3, -1
    v_ldexp_f32 v8, v9, s15
    v_rndne_f32 v8, v8
    v_cvt_u32_f32 v8, v8
    s_bfe_u32 s15, s12, 524296
    v_add_u32 v8, s15, v8
    v_mad_u32_u24 v133, v8, s14, v10
    s_cmp_lg_u32 s13, 0
    s_cselect_b32 s15, -3, -2
    v_ldexp_f32 v8, v9, s15
    v_rndne_f32 v8, v8
    v_cvt_u32_f32 v8, v8
    s_bfe_u32 s15, s12, 524304
    v_add_u32 v8, s15, v8
    v_mad_u32_u24 v134, v8, s14, v10
    s_cmp_lg_u32 s13, 0
    s_cselect_b32 s15, -3, -2
    v_ldexp_f32 v8, v9, s15
    v_rndne_f32 v8, v8
    v_cvt_u32_f32 v8, v8
    s_bfe_u32 s15, s12, 524312
    v_add_u32 v8, s15, v8
    v_mad_u32_u24 v135, v8, s14, v10
    s_barrier
m_tab:
    s_lshr_b32 s14, s3, 1
    s_mul_i32 s15, s14, 33792
    s_add_u32 s15, s15, 73728
    v_lshl_add_u32 v123, v19, 1, s15
    s_waitcnt lgkmcnt(0)
    s_and_b32 s12, s65, 0xffff0000
    s_lshl_b32 s13, s65, 16
    s_cmp_lg_u32 s14, 0
    s_cselect_b32 s12, s12, s13
    v_mov_b32 v122, s12
    v_mul_f32 v122, s66, v122
    v_exp_f32 v122, v122
    v_mov_b32 v131, 0x3f80
    ds_write_b32 v123, v131 offset:0
    v_cvt_pk_bf16_f32 v122, v122, v122
    v_lshlrev_b32 v122, 16, v122
    s_mov_b32 s12, 1042479491
    s_waitcnt vmcnt(5)
    v_lshlrev_b32 v120, 16, v138
    s_waitcnt vmcnt(4)
    v_lshlrev_b32 v121, 16, v139
    v_mul_f32 v120, v122, v120
    v_mul_f32 v121, v122, v121
    v_mul_f32 v120, s66, v120
    v_mul_f32 v121, s12, v121
    v_mul_f32 v114, 1.0, v120
    v_mul_f32 v115, 1.0, v121
    v_exp_f32 v114, v114
    v_fract_f32 v115, v115
    v_cos_f32 v74, v115
    v_sin_f32 v75, v115
    v_mul_f32 v116, 0x41800000, v120
    v_mul_f32 v117, 0x41800000, v121
    v_exp_f32 v116, v116
    v_fract_f32 v117, v117
    v_cos_f32 v104, v117
    v_sin_f32 v105, v117
    v_mul_f32 v106, 0x43800000, v120
    v_mul_f32 v107, 0x43800000, v121
    v_exp_f32 v106, v106
    v_fract_f32 v107, v107
    v_cos_f32 v108, v107
    v_sin_f32 v109, v107
    s_waitcnt vmcnt(3)
    v_lshlrev_b32 v110, 16, v140
    s_waitcnt vmcnt(2)
    v_lshlrev_b32 v111, 16, v141
    s_waitcnt vmcnt(1)
    v_lshlrev_b32 v112, 16, v142
    s_waitcnt vmcnt(0)
    v_lshlrev_b32 v113, 16, v143
    v_mul_f32 v110, v122, v110
    v_mul_f32 v111, v122, v111
    v_pk_mul_f32 v[74:75], v[74:75], v[114:115] op_sel:[0,0] op_sel_hi:[1,0]
    v_pk_mul_f32 v[104:105], v[104:105], v[116:117] op_sel:[0,0] op_sel_hi:[1,0]
    v_pk_mul_f32 v[108:109], v[108:109], v[106:107] op_sel:[0,0] op_sel_hi:[1,0]
    v_pk_mul_f32 v[114:115], v[110:111], v[112:113] op_sel:[0,0] op_sel_hi:[1,0]
    v_pk_fma_f32 v[110:111], v[110:111], v[112:113], v[114:115] op_sel:[1,1,0] op_sel_hi:[0,1,1] neg_lo:[1,0,0]
    v_xor_b32 v111, 0x80000000, v111
    v_mov_b32 v118, v104
    v_xor_b32 v119, 0x80000000, v105
    v_cvt_pk_bf16_f32 v124, v74, v75
    ds_write_b32 v123, v124 offset:544
    v_cvt_pk_bf16_f32 v125, v110, v111
    ds_write_b32 v123, v125 offset:25568
    v_pk_mul_f32 v[76:77], v[74:75], v[74:75] op_sel:[0,0] op_sel_hi:[1,0]
    v_pk_fma_f32 v[76:77], v[74:75], v[74:75], v[76:77] op_sel:[1,1,0] op_sel_hi:[0,1,1] neg_lo:[1,0,0]
    v_pk_mul_f32 v[114:115], v[110:111], v[118:119] op_sel:[0,0] op_sel_hi:[1,0]
    v_pk_fma_f32 v[110:111], v[110:111], v[118:119], v[114:115] op_sel:[1,1,0] op_sel_hi:[0,1,1] neg_lo:[1,0,0]
    v_cvt_pk_bf16_f32 v126, v76, v77
    ds_write_b32 v123, v126 offset:1088
    v_cvt_pk_bf16_f32 v127, v110, v111
    ds_write_b32 v123, v127 offset:26112
    v_pk_mul_f32 v[78:79], v[74:75], v[76:77] op_sel:[0,0] op_sel_hi:[1,0]
    v_pk_fma_f32 v[78:79], v[74:75], v[76:77], v[78:79] op_sel:[1,1,0] op_sel_hi:[0,1,1] neg_lo:[1,0,0]
    v_pk_mul_f32 v[114:115], v[110:111], v[118:119] op_sel:[0,0] op_sel_hi:[1,0]
    v_pk_fma_f32 v[110:111], v[110:111], v[118:119], v[114:115] op_sel:[1,1,0] op_sel_hi:[0,1,1] neg_lo:[1,0,0]
    v_cvt_pk_bf16_f32 v128, v78, v79
    ds_write_b32 v123, v128 offset:1632
    v_cvt_pk_bf16_f32 v129, v110, v111
    ds_write_b32 v123, v129 offset:26656
    v_pk_mul_f32 v[80:81], v[76:77], v[76:77] op_sel:[0,0] op_sel_hi:[1,0]
    v_pk_fma_f32 v[80:81], v[76:77], v[76:77], v[80:81] op_sel:[1,1,0] op_sel_hi:[0,1,1] neg_lo:[1,0,0]
    v_pk_mul_f32 v[114:115], v[110:111], v[118:119] op_sel:[0,0] op_sel_hi:[1,0]
    v_pk_fma_f32 v[110:111], v[110:111], v[118:119], v[114:115] op_sel:[1,1,0] op_sel_hi:[0,1,1] neg_lo:[1,0,0]
    v_cvt_pk_bf16_f32 v130, v80, v81
    ds_write_b32 v123, v130 offset:2176
    v_cvt_pk_bf16_f32 v124, v110, v111
    ds_write_b32 v123, v124 offset:27200
    v_pk_mul_f32 v[82:83], v[76:77], v[78:79] op_sel:[0,0] op_sel_hi:[1,0]
    v_pk_fma_f32 v[82:83], v[76:77], v[78:79], v[82:83] op_sel:[1,1,0] op_sel_hi:[0,1,1] neg_lo:[1,0,0]
    v_pk_mul_f32 v[114:115], v[110:111], v[118:119] op_sel:[0,0] op_sel_hi:[1,0]
    v_pk_fma_f32 v[110:111], v[110:111], v[118:119], v[114:115] op_sel:[1,1,0] op_sel_hi:[0,1,1] neg_lo:[1,0,0]
    v_cvt_pk_bf16_f32 v125, v82, v83
    ds_write_b32 v123, v125 offset:2720
    v_cvt_pk_bf16_f32 v126, v110, v111
    ds_write_b32 v123, v126 offset:27744
    v_pk_mul_f32 v[84:85], v[78:79], v[78:79] op_sel:[0,0] op_sel_hi:[1,0]
    v_pk_fma_f32 v[84:85], v[78:79], v[78:79], v[84:85] op_sel:[1,1,0] op_sel_hi:[0,1,1] neg_lo:[1,0,0]
    v_pk_mul_f32 v[114:115], v[110:111], v[118:119] op_sel:[0,0] op_sel_hi:[1,0]
    v_pk_fma_f32 v[110:111], v[110:111], v[118:119], v[114:115] op_sel:[1,1,0] op_sel_hi:[0,1,1] neg_lo:[1,0,0]
    v_cvt_pk_bf16_f32 v127, v84, v85
    ds_write_b32 v123, v127 offset:3264
    v_cvt_pk_bf16_f32 v128, v110, v111
    ds_write_b32 v123, v128 offset:28288
    v_pk_mul_f32 v[86:87], v[78:79], v[80:81] op_sel:[0,0] op_sel_hi:[1,0]
    v_pk_fma_f32 v[86:87], v[78:79], v[80:81], v[86:87] op_sel:[1,1,0] op_sel_hi:[0,1,1] neg_lo:[1,0,0]
    v_pk_mul_f32 v[114:115], v[110:111], v[118:119] op_sel:[0,0] op_sel_hi:[1,0]
    v_pk_fma_f32 v[110:111], v[110:111], v[118:119], v[114:115] op_sel:[1,1,0] op_sel_hi:[0,1,1] neg_lo:[1,0,0]
    v_cvt_pk_bf16_f32 v129, v86, v87
    ds_write_b32 v123, v129 offset:3808
    v_cvt_pk_bf16_f32 v130, v110, v111
    ds_write_b32 v123, v130 offset:28832
    v_pk_mul_f32 v[88:89], v[80:81], v[80:81] op_sel:[0,0] op_sel_hi:[1,0]
    v_pk_fma_f32 v[88:89], v[80:81], v[80:81], v[88:89] op_sel:[1,1,0] op_sel_hi:[0,1,1] neg_lo:[1,0,0]
    v_pk_mul_f32 v[114:115], v[110:111], v[118:119] op_sel:[0,0] op_sel_hi:[1,0]
    v_pk_fma_f32 v[110:111], v[110:111], v[118:119], v[114:115] op_sel:[1,1,0] op_sel_hi:[0,1,1] neg_lo:[1,0,0]
    v_cvt_pk_bf16_f32 v124, v88, v89
    ds_write_b32 v123, v124 offset:4352
    v_cvt_pk_bf16_f32 v125, v110, v111
    ds_write_b32 v123, v125 offset:29376
    v_pk_mul_f32 v[90:91], v[80:81], v[82:83] op_sel:[0,0] op_sel_hi:[1,0]
    v_pk_fma_f32 v[90:91], v[80:81], v[82:83], v[90:91] op_sel:[1,1,0] op_sel_hi:[0,1,1] neg_lo:[1,0,0]
    v_pk_mul_f32 v[114:115], v[110:111], v[118:119] op_sel:[0,0] op_sel_hi:[1,0]
    v_pk_fma_f32 v[110:111], v[110:111], v[118:119], v[114:115] op_sel:[1,1,0] op_sel_hi:[0,1,1] neg_lo:[1,0,0]
    v_cvt_pk_bf16_f32 v126, v90, v91
    ds_write_b32 v123, v126 offset:4896
    v_cvt_pk_bf16_f32 v127, v110, v111
    ds_write_b32 v123, v127 offset:29920
    v_pk_mul_f32 v[92:93], v[82:83], v[82:83] op_sel:[0,0] op_sel_hi:[1,0]
    v_pk_fma_f32 v[92:93], v[82:83], v[82:83], v[92:93] op_sel:[1,1,0] op_sel_hi:[0,1,1] neg_lo:[1,0,0]
    v_pk_mul_f32 v[114:115], v[110:111], v[118:119] op_sel:[0,0] op_sel_hi:[1,0]
    v_pk_fma_f32 v[110:111], v[110:111], v[118:119], v[114:115] op_sel:[1,1,0] op_sel_hi:[0,1,1] neg_lo:[1,0,0]
    v_cvt_pk_bf16_f32 v128, v92, v93
    ds_write_b32 v123, v128 offset:5440
    v_cvt_pk_bf16_f32 v129, v110, v111
    ds_write_b32 v123, v129 offset:30464
    v_pk_mul_f32 v[94:95], v[82:83], v[84:85] op_sel:[0,0] op_sel_hi:[1,0]
    v_pk_fma_f32 v[94:95], v[82:83], v[84:85], v[94:95] op_sel:[1,1,0] op_sel_hi:[0,1,1] neg_lo:[1,0,0]
    v_pk_mul_f32 v[114:115], v[110:111], v[118:119] op_sel:[0,0] op_sel_hi:[1,0]
    v_pk_fma_f32 v[110:111], v[110:111], v[118:119], v[114:115] op_sel:[1,1,0] op_sel_hi:[0,1,1] neg_lo:[1,0,0]
    v_cvt_pk_bf16_f32 v130, v94, v95
    ds_write_b32 v123, v130 offset:5984
    v_cvt_pk_bf16_f32 v124, v110, v111
    ds_write_b32 v123, v124 offset:31008
    v_pk_mul_f32 v[96:97], v[84:85], v[84:85] op_sel:[0,0] op_sel_hi:[1,0]
    v_pk_fma_f32 v[96:97], v[84:85], v[84:85], v[96:97] op_sel:[1,1,0] op_sel_hi:[0,1,1] neg_lo:[1,0,0]
    v_pk_mul_f32 v[114:115], v[110:111], v[118:119] op_sel:[0,0] op_sel_hi:[1,0]
    v_pk_fma_f32 v[110:111], v[110:111], v[118:119], v[114:115] op_sel:[1,1,0] op_sel_hi:[0,1,1] neg_lo:[1,0,0]
    v_cvt_pk_bf16_f32 v125, v96, v97
    ds_write_b32 v123, v125 offset:6528
    v_cvt_pk_bf16_f32 v126, v110, v111
    ds_write_b32 v123, v126 offset:31552
    v_pk_mul_f32 v[98:99], v[84:85], v[86:87] op_sel:[0,0] op_sel_hi:[1,0]
    v_pk_fma_f32 v[98:99], v[84:85], v[86:87], v[98:99] op_sel:[1,1,0] op_sel_hi:[0,1,1] neg_lo:[1,0,0]
    v_pk_mul_f32 v[114:115], v[110:111], v[118:119] op_sel:[0,0] op_sel_hi:[1,0]
    v_pk_fma_f32 v[110:111], v[110:111], v[118:119], v[114:115] op_sel:[1,1,0] op_sel_hi:[0,1,1] neg_lo:[1,0,0]
    v_cvt_pk_bf16_f32 v127, v98, v99
    ds_write_b32 v123, v127 offset:7072
    v_cvt_pk_bf16_f32 v128, v110, v111
    ds_write_b32 v123, v128 offset:32096
    v_pk_mul_f32 v[100:101], v[86:87], v[86:87] op_sel:[0,0] op_sel_hi:[1,0]
    v_pk_fma_f32 v[100:101], v[86:87], v[86:87], v[100:101] op_sel:[1,1,0] op_sel_hi:[0,1,1] neg_lo:[1,0,0]
    v_pk_mul_f32 v[114:115], v[110:111], v[118:119] op_sel:[0,0] op_sel_hi:[1,0]
    v_pk_fma_f32 v[110:111], v[110:111], v[118:119], v[114:115] op_sel:[1,1,0] op_sel_hi:[0,1,1] neg_lo:[1,0,0]
    v_cvt_pk_bf16_f32 v129, v100, v101
    ds_write_b32 v123, v129 offset:7616
    v_cvt_pk_bf16_f32 v130, v110, v111
    ds_write_b32 v123, v130 offset:32640
    v_pk_mul_f32 v[102:103], v[86:87], v[88:89] op_sel:[0,0] op_sel_hi:[1,0]
    v_pk_fma_f32 v[102:103], v[86:87], v[88:89], v[102:103] op_sel:[1,1,0] op_sel_hi:[0,1,1] neg_lo:[1,0,0]
    v_pk_mul_f32 v[114:115], v[110:111], v[118:119] op_sel:[0,0] op_sel_hi:[1,0]
    v_pk_fma_f32 v[110:111], v[110:111], v[118:119], v[114:115] op_sel:[1,1,0] op_sel_hi:[0,1,1] neg_lo:[1,0,0]
    v_cvt_pk_bf16_f32 v124, v102, v103
    ds_write_b32 v123, v124 offset:8160
    v_cvt_pk_bf16_f32 v125, v110, v111
    ds_write_b32 v123, v125 offset:33184
    v_pk_mul_f32 v[114:115], v[110:111], v[118:119] op_sel:[0,0] op_sel_hi:[1,0]
    v_pk_fma_f32 v[110:111], v[110:111], v[118:119], v[114:115] op_sel:[1,1,0] op_sel_hi:[0,1,1] neg_lo:[1,0,0]
    v_cvt_pk_bf16_f32 v126, v110, v111
    ds_write_b32 v123, v126 offset:33728
    v_cvt_pk_bf16_f32 v127, v108, v109
    ds_write_b32 v123, v127 offset:8704
    v_pk_mul_f32 v[112:113], v[108:109], v[76:77] op_sel:[0,0] op_sel_hi:[1,0]
    v_pk_fma_f32 v[112:113], v[108:109], v[76:77], v[112:113] op_sel:[1,1,0] op_sel_hi:[0,1,1] neg_lo:[1,0,0]
    v_cvt_pk_bf16_f32 v128, v112, v113
    ds_write_b32 v123, v128 offset:9248
    v_pk_mul_f32 v[116:117], v[108:109], v[80:81] op_sel:[0,0] op_sel_hi:[1,0]
    v_pk_fma_f32 v[116:117], v[108:109], v[80:81], v[116:117] op_sel:[1,1,0] op_sel_hi:[0,1,1] neg_lo:[1,0,0]
    v_cvt_pk_bf16_f32 v129, v116, v117
    ds_write_b32 v123, v129 offset:9792
    v_pk_mul_f32 v[112:113], v[108:109], v[84:85] op_sel:[0,0] op_sel_hi:[1,0]
    v_pk_fma_f32 v[112:113], v[108:109], v[84:85], v[112:113] op_sel:[1,1,0] op_sel_hi:[0,1,1] neg_lo:[1,0,0]
    v_cvt_pk_bf16_f32 v130, v112, v113
    ds_write_b32 v123, v130 offset:10336
    v_pk_mul_f32 v[116:117], v[108:109], v[88:89] op_sel:[0,0] op_sel_hi:[1,0]
    v_pk_fma_f32 v[116:117], v[108:109], v[88:89], v[116:117] op_sel:[1,1,0] op_sel_hi:[0,1,1] neg_lo:[1,0,0]
    v_cvt_pk_bf16_f32 v124, v116, v117
    ds_write_b32 v123, v124 offset:10880
    v_pk_mul_f32 v[112:113], v[108:109], v[92:93] op_sel:[0,0] op_sel_hi:[1,0]
    v_pk_fma_f32 v[112:113], v[108:109], v[92:93], v[112:113] op_sel:[1,1,0] op_sel_hi:[0,1,1] neg_lo:[1,0,0]
    v_cvt_pk_bf16_f32 v125, v112, v113
    ds_write_b32 v123, v125 offset:11424
    v_pk_mul_f32 v[116:117], v[108:109], v[96:97] op_sel:[0,0] op_sel_hi:[1,0]
    v_pk_fma_f32 v[116:117], v[108:109], v[96:97], v[116:117] op_sel:[1,1,0] op_sel_hi:[0,1,1] neg_lo:[1,0,0]
    v_cvt_pk_bf16_f32 v126, v116, v117
    ds_write_b32 v123, v126 offset:11968
    v_pk_mul_f32 v[112:113], v[108:109], v[100:101] op_sel:[0,0] op_sel_hi:[1,0]
    v_pk_fma_f32 v[112:113], v[108:109], v[100:101], v[112:113] op_sel:[1,1,0] op_sel_hi:[0,1,1] neg_lo:[1,0,0]
    v_cvt_pk_bf16_f32 v127, v112, v113
    ds_write_b32 v123, v127 offset:12512
    v_pk_mul_f32 v[116:117], v[108:109], v[104:105] op_sel:[0,0] op_sel_hi:[1,0]
    v_pk_fma_f32 v[116:117], v[108:109], v[104:105], v[116:117] op_sel:[1,1,0] op_sel_hi:[0,1,1] neg_lo:[1,0,0]
    v_cvt_pk_bf16_f32 v128, v116, v117
    ds_write_b32 v123, v128 offset:13056
    v_pk_mul_f32 v[114:115], v[108:109], v[108:109] op_sel:[0,0] op_sel_hi:[1,0]
    v_pk_fma_f32 v[106:107], v[108:109], v[108:109], v[114:115] op_sel:[1,1,0] op_sel_hi:[0,1,1] neg_lo:[1,0,0]
    v_cvt_pk_bf16_f32 v129, v106, v107
    ds_write_b32 v123, v129 offset:13600
    v_pk_mul_f32 v[112:113], v[106:107], v[80:81] op_sel:[0,0] op_sel_hi:[1,0]
    v_pk_fma_f32 v[112:113], v[106:107], v[80:81], v[112:113] op_sel:[1,1,0] op_sel_hi:[0,1,1] neg_lo:[1,0,0]
    v_cvt_pk_bf16_f32 v130, v112, v113
    ds_write_b32 v123, v130 offset:14144
    v_pk_mul_f32 v[116:117], v[106:107], v[88:89] op_sel:[0,0] op_sel_hi:[1,0]
    v_pk_fma_f32 v[116:117], v[106:107], v[88:89], v[116:117] op_sel:[1,1,0] op_sel_hi:[0,1,1] neg_lo:[1,0,0]
    v_cvt_pk_bf16_f32 v124, v116, v117
    ds_write_b32 v123, v124 offset:14688
    v_pk_mul_f32 v[112:113], v[106:107], v[96:97] op_sel:[0,0] op_sel_hi:[1,0]
    v_pk_fma_f32 v[112:113], v[106:107], v[96:97], v[112:113] op_sel:[1,1,0] op_sel_hi:[0,1,1] neg_lo:[1,0,0]
    v_cvt_pk_bf16_f32 v125, v112, v113
    ds_write_b32 v123, v125 offset:15232
    v_pk_mul_f32 v[116:117], v[106:107], v[104:105] op_sel:[0,0] op_sel_hi:[1,0]
    v_pk_fma_f32 v[116:117], v[106:107], v[104:105], v[116:117] op_sel:[1,1,0] op_sel_hi:[0,1,1] neg_lo:[1,0,0]
    v_cvt_pk_bf16_f32 v126, v116, v117
    ds_write_b32 v123, v126 offset:15776
    v_pk_mul_f32 v[114:115], v[106:107], v[108:109] op_sel:[0,0] op_sel_hi:[1,0]
    v_pk_fma_f32 v[106:107], v[106:107], v[108:109], v[114:115] op_sel:[1,1,0] op_sel_hi:[0,1,1] neg_lo:[1,0,0]
    v_cvt_pk_bf16_f32 v127, v106, v107
    ds_write_b32 v123, v127 offset:16320
    v_pk_mul_f32 v[112:113], v[106:107], v[80:81] op_sel:[0,0] op_sel_hi:[1,0]
    v_pk_fma_f32 v[112:113], v[106:107], v[80:81], v[112:113] op_sel:[1,1,0] op_sel_hi:[0,1,1] neg_lo:[1,0,0]
    v_cvt_pk_bf16_f32 v128, v112, v113
    ds_write_b32 v123, v128 offset:16864
    v_pk_mul_f32 v[116:117], v[106:107], v[88:89] op_sel:[0,0] op_sel_hi:[1,0]
    v_pk_fma_f32 v[116:117], v[106:107], v[88:89], v[116:117] op_sel:[1,1,0] op_sel_hi:[0,1,1] neg_lo:[1,0,0]
    v_cvt_pk_bf16_f32 v129, v116, v117
    ds_write_b32 v123, v129 offset:17408
    v_pk_mul_f32 v[112:113], v[106:107], v[96:97] op_sel:[0,0] op_sel_hi:[1,0]
    v_pk_fma_f32 v[112:113], v[106:107], v[96:97], v[112:113] op_sel:[1,1,0] op_sel_hi:[0,1,1] neg_lo:[1,0,0]
    v_cvt_pk_bf16_f32 v130, v112, v113
    ds_write_b32 v123, v130 offset:17952
    v_pk_mul_f32 v[116:117], v[106:107], v[104:105] op_sel:[0,0] op_sel_hi:[1,0]
    v_pk_fma_f32 v[116:117], v[106:107], v[104:105], v[116:117] op_sel:[1,1,0] op_sel_hi:[0,1,1] neg_lo:[1,0,0]
    v_cvt_pk_bf16_f32 v124, v116, v117
    ds_write_b32 v123, v124 offset:18496
    v_pk_mul_f32 v[114:115], v[106:107], v[108:109] op_sel:[0,0] op_sel_hi:[1,0]
    v_pk_fma_f32 v[106:107], v[106:107], v[108:109], v[114:115] op_sel:[1,1,0] op_sel_hi:[0,1,1] neg_lo:[1,0,0]
    v_cvt_pk_bf16_f32 v125, v106, v107
    ds_write_b32 v123, v125 offset:19040
    v_pk_mul_f32 v[112:113], v[106:107], v[88:89] op_sel:[0,0] op_sel_hi:[1,0]
    v_pk_fma_f32 v[112:113], v[106:107], v[88:89], v[112:113] op_sel:[1,1,0] op_sel_hi:[0,1,1] neg_lo:[1,0,0]
    v_cvt_pk_bf16_f32 v126, v112, v113
    ds_write_b32 v123, v126 offset:19584
    v_pk_mul_f32 v[116:117], v[106:107], v[104:105] op_sel:[0,0] op_sel_hi:[1,0]
    v_pk_fma_f32 v[116:117], v[106:107], v[104:105], v[116:117] op_sel:[1,1,0] op_sel_hi:[0,1,1] neg_lo:[1,0,0]
    v_cvt_pk_bf16_f32 v127, v116, v117
    ds_write_b32 v123, v127 offset:20128
    v_pk_mul_f32 v[114:115], v[106:107], v[108:109] op_sel:[0,0] op_sel_hi:[1,0]
    v_pk_fma_f32 v[106:107], v[106:107], v[108:109], v[114:115] op_sel:[1,1,0] op_sel_hi:[0,1,1] neg_lo:[1,0,0]
    v_cvt_pk_bf16_f32 v128, v106, v107
    ds_write_b32 v123, v128 offset:20672
    v_pk_mul_f32 v[112:113], v[106:107], v[88:89] op_sel:[0,0] op_sel_hi:[1,0]
    v_pk_fma_f32 v[112:113], v[106:107], v[88:89], v[112:113] op_sel:[1,1,0] op_sel_hi:[0,1,1] neg_lo:[1,0,0]
    v_cvt_pk_bf16_f32 v129, v112, v113
    ds_write_b32 v123, v129 offset:21216
    v_pk_mul_f32 v[116:117], v[106:107], v[104:105] op_sel:[0,0] op_sel_hi:[1,0]
    v_pk_fma_f32 v[116:117], v[106:107], v[104:105], v[116:117] op_sel:[1,1,0] op_sel_hi:[0,1,1] neg_lo:[1,0,0]
    v_cvt_pk_bf16_f32 v130, v116, v117
    ds_write_b32 v123, v130 offset:21760
    v_pk_mul_f32 v[114:115], v[106:107], v[108:109] op_sel:[0,0] op_sel_hi:[1,0]
    v_pk_fma_f32 v[106:107], v[106:107], v[108:109], v[114:115] op_sel:[1,1,0] op_sel_hi:[0,1,1] neg_lo:[1,0,0]
    v_cvt_pk_bf16_f32 v124, v106, v107
    ds_write_b32 v123, v124 offset:22304
    v_pk_mul_f32 v[112:113], v[106:107], v[88:89] op_sel:[0,0] op_sel_hi:[1,0]
    v_pk_fma_f32 v[112:113], v[106:107], v[88:89], v[112:113] op_sel:[1,1,0] op_sel_hi:[0,1,1] neg_lo:[1,0,0]
    v_cvt_pk_bf16_f32 v125, v112, v113
    ds_write_b32 v123, v125 offset:22848
    v_pk_mul_f32 v[116:117], v[106:107], v[104:105] op_sel:[0,0] op_sel_hi:[1,0]
    v_pk_fma_f32 v[116:117], v[106:107], v[104:105], v[116:117] op_sel:[1,1,0] op_sel_hi:[0,1,1] neg_lo:[1,0,0]
    v_cvt_pk_bf16_f32 v126, v116, v117
    ds_write_b32 v123, v126 offset:23392
    v_pk_mul_f32 v[114:115], v[106:107], v[108:109] op_sel:[0,0] op_sel_hi:[1,0]
    v_pk_fma_f32 v[106:107], v[106:107], v[108:109], v[114:115] op_sel:[1,1,0] op_sel_hi:[0,1,1] neg_lo:[1,0,0]
    v_cvt_pk_bf16_f32 v127, v106, v107
    ds_write_b32 v123, v127 offset:23936
    v_pk_mul_f32 v[112:113], v[106:107], v[88:89] op_sel:[0,0] op_sel_hi:[1,0]
    v_pk_fma_f32 v[112:113], v[106:107], v[88:89], v[112:113] op_sel:[1,1,0] op_sel_hi:[0,1,1] neg_lo:[1,0,0]
    v_cvt_pk_bf16_f32 v128, v112, v113
    ds_write_b32 v123, v128 offset:24480
    v_pk_mul_f32 v[116:117], v[106:107], v[104:105] op_sel:[0,0] op_sel_hi:[1,0]
    v_pk_fma_f32 v[116:117], v[106:107], v[104:105], v[116:117] op_sel:[1,1,0] op_sel_hi:[0,1,1] neg_lo:[1,0,0]
    v_cvt_pk_bf16_f32 v129, v116, v117
    ds_write_b32 v123, v129 offset:25024
    v_mov_b32 v8, 163812
    s_add_u32 s55, s55, 4
    s_waitcnt lgkmcnt(0)
    s_mov_b64 exec, 1
    ds_add_u32 v8, v12
    s_mov_b64 exec, -1
    s_cmp_lt_u32 s7, 6
    s_cbranch_scc1 m_kmm
    s_cmp_lg_u32 s68, 0
    s_cbranch_scc1 m_kmm
    s_add_u32 s64, s64, 1
    s_lshl_b32 s12, s64, 9
    s_lshl_b32 s13, s64, 2
    s_load_dword s65, s[38:39], s13
    v_add_u32 v8, s12, v19
    global_load_ushort v138, v8, s[26:27]
    global_load_ushort v139, v8, s[28:29]
    global_load_ushort v140, v8, s[30:31]
    global_load_ushort v141, v8, s[32:33]
    global_load_ushort v142, v8, s[34:35]
    global_load_ushort v143, v8, s[36:37]
m_kmm:
    v_mov_b32 v8, 163812
m_lb1:
    ds_read_b32 v9, v8
    s_waitcnt lgkmcnt(0)
    v_readfirstlane_b32 s12, v9
    s_nop 0
    s_cmp_lt_u32 s12, s55
    s_cbranch_scc1 m_lb1
    ds_read_b128 v[72:75], v136 offset:25568
    ds_read_b128 v[20:23], v132 offset:0
    ds_read_b128 v[24:27], v133 offset:0
    ds_read_b128 v[28:31], v134 offset:0
    ds_read_b128 v[32:35], v135 offset:0
    ds_read_b128 v[76:79], v136 offset:25632
    ds_read_b128 v[36:39], v132 offset:64
    ds_read_b128 v[40:43], v133 offset:64
    ds_read_b128 v[44:47], v134 offset:64
    ds_read_b128 v[48:51], v135 offset:64
    ds_read_b128 v[80:83], v136 offset:25696
    ds_read_b128 v[52:55], v132 offset:128
    ds_read_b128 v[56:59], v133 offset:128
    ds_read_b128 v[60:63], v134 offset:128
    s_lshr_b32 s13, s70, 1
    v_lshrrev_b32 v8, 1, v3
    v_xor_b32 v8, v8, v4
    s_waitcnt lgkmcnt(12)
    v_mfma_f32_16x16x32_bf16 v[232:235], v[20:23], v[72:75], 0
    ds_read_b128 v[64:67], v135 offset:128
    v_lshlrev_b32 v9, 7, v3
    s_and_b32 s12, s70, 1
    s_lshl_b32 s12, s12, 13
    s_waitcnt lgkmcnt(12)
    v_mfma_f32_16x16x32_bf16 v[236:239], v[24:27], v[72:75], 0
    ds_read_b128 v[84:87], v136 offset:25760
    ds_read_b128 v[20:23], v132 offset:192
    v_add_u32 v9, s12, v9
    v_lshl_add_u32 v224, v8, 4, v9
    v_xor_b32 v8, 4, v8
    s_waitcnt lgkmcnt(13)
    v_mfma_f32_16x16x32_bf16 v[240:243], v[28:31], v[72:75], 0
    ds_read_b128 v[24:27], v133 offset:192
    v_lshl_add_u32 v225, v8, 4, v9
    v_lshl_add_u32 v8, v4, 3, v5
    v_mul_u32_u24 v8, 320, v8
    s_waitcnt lgkmcnt(13)
    v_mfma_f32_16x16x32_bf16 v[244:247], v[32:35], v[72:75], 0
    ds_read_b128 v[28:31], v134 offset:192
    v_mul_u32_u24 v9, 40, v6
    v_add_u32 v8, v8, v9
    v_and_b32 v9, 1, v4
    s_waitcnt lgkmcnt(12)
    v_mfma_f32_16x16x32_bf16 v[232:235], v[36:39], v[76:79], v[232:235]
    ds_read_b128 v[32:35], v135 offset:192
    v_lshl_add_u32 v8, v9, 5, v8
    s_mul_i32 s12, s13, 160
    s_add_u32 s12, s12, 16384
    s_waitcnt lgkmcnt(12)
    v_mfma_f32_16x16x32_bf16 v[236:239], v[40:43], v[76:79], v[236:239]
    ds_read_b128 v[88:91], v136 offset:25824
    ds_read_b128 v[36:39], v132 offset:256
    v_add_u32 v226, s12, v8
    s_mul_i32 s12, s13, 320
    v_and_b32 v8, 19, v1
    s_waitcnt lgkmcnt(13)
    v_mfma_f32_16x16x32_bf16 v[240:243], v[44:47], v[76:79], v[240:243]
    ds_read_b128 v[40:43], v133 offset:256
    v_subrev_u32 v9, s12, v226
    v_cmp_eq_u32 vcc, 19, v8
    s_nop 1
    v_cndmask_b32 v227, v226, v9, vcc
    s_waitcnt lgkmcnt(13)
    v_mfma_f32_16x16x32_bf16 v[244:247], v[48:51], v[76:79], v[244:247]
    ds_read_b128 v[44:47], v134 offset:256
    v_mov_b32 v228, v224
    v_mov_b32 v229, v225
    v_mov_b32 v230, v226
    s_waitcnt lgkmcnt(12)
    v_mfma_f32_16x16x32_bf16 v[232:235], v[52:55], v[80:83], v[232:235]
    ds_read_b128 v[48:51], v135 offset:256
    v_mov_b32 v231, v227
    s_mov_b32 s12, 0
    v_mul_u32_u24 v8, 800, v4
    s_waitcnt lgkmcnt(12)
    v_mfma_f32_16x16x32_bf16 v[236:239], v[56:59], v[80:83], v[236:239]
    ds_read_b128 v[92:95], v136 offset:25888
    ds_read_b128 v[52:55], v132 offset:320
    v_mul_u32_u24 v9, 40, v5
    v_add3_u32 v8, v8, v9, s12
    v_mov_b32 v16, 3200
    s_waitcnt lgkmcnt(13)
    v_mfma_f32_16x16x32_bf16 v[240:243], v[60:63], v[80:83], v[240:243]
    ds_read_b128 v[56:59], v133 offset:320
    v_cmp_eq_u32 vcc, v6, v4
    s_nop 1
    v_cndmask_b32 v16, v16, v8, vcc
    v_add_u32 v16, 147456, v16
    s_waitcnt lgkmcnt(13)
    v_mfma_f32_16x16x32_bf16 v[244:247], v[64:67], v[80:83], v[244:247]
    ds_read_b128 v[60:63], v134 offset:320
    s_and_b32 s12, s4, 3
    s_lshl_b32 s12, s12, 5
    s_lshr_b32 s13, s4, 2
    s_waitcnt lgkmcnt(12)
    v_mfma_f32_16x16x32_bf16 v[232:235], v[20:23], v[84:87], v[232:235]
    ds_read_b128 v[64:67], v135 offset:320
    s_add_u32 s12, s12, s13
    s_add_u32 s12, s12, 256
    v_lshl_add_u32 v253, v6, 3, s12
    s_waitcnt lgkmcnt(12)
    v_mfma_f32_16x16x32_bf16 v[236:239], v[24:27], v[84:87], v[236:239]
    ds_read_b128 v[96:99], v136 offset:25952
    ds_read_b128 v[20:23], v132 offset:384
    v_lshl_add_u32 v253, v5, 1, v253
    s_lshr_b32 s13, s5, 3
    s_mul_i32 s13, s13, 10
    s_waitcnt lgkmcnt(13)
    v_mfma_f32_16x16x32_bf16 v[240:243], v[28:31], v[84:87], v[240:243]
    ds_read_b128 v[24:27], v133 offset:384
    s_add_u32 s13, s13, 448
    v_min_u32 v8, 9, v3
    v_cmp_le_u32 vcc, 32, v1
    s_waitcnt lgkmcnt(13)
    v_mfma_f32_16x16x32_bf16 v[244:247], v[32:35], v[84:87], v[244:247]
    ds_read_b128 v[28:31], v134 offset:384
    v_add_u32 v8, s13, v8
    v_lshlrev_b32 v11, 7, v8
    v_cndmask_b32 v253, v253, v8, vcc
    s_waitcnt lgkmcnt(12)
    v_mfma_f32_16x16x32_bf16 v[232:235], v[36:39], v[88:91], v[232:235]
    ds_read_b128 v[32:35], v135 offset:384
    v_lshlrev_b32 v253, 7, v253
    s_cmp_lg_u32 s69, 0
    s_cselect_b64 vcc, -1, 0
    s_waitcnt lgkmcnt(12)
    v_mfma_f32_16x16x32_bf16 v[236:239], v[40:43], v[88:91], v[236:239]
    ds_read_b128 v[100:103], v136 offset:26016
    ds_read_b128 v[36:39], v132 offset:448
    s_lshr_b32 s12, s5, 2
    s_lshl_b32 s12, s12, 1
    s_lshr_b32 s13, s70, 1
    s_waitcnt lgkmcnt(13)
    v_mfma_f32_16x16x32_bf16 v[240:243], v[44:47], v[88:91], v[240:243]
    ds_read_b128 v[40:43], v133 offset:448
    s_add_u32 s12, s12, s13
    s_and_b32 s13, s12, 3
    s_lshl_b32 s13, s13, 3
    s_waitcnt lgkmcnt(13)
    v_mfma_f32_16x16x32_bf16 v[244:247], v[48:51], v[88:91], v[244:247]
    ds_read_b128 v[44:47], v134 offset:448
    s_lshr_b32 s12, s12, 2
    s_lshl_b32 s12, s12, 1
    s_add_u32 s12, s12, s13
    s_waitcnt lgkmcnt(12)
    v_mfma_f32_16x16x32_bf16 v[232:235], v[52:55], v[92:95], v[232:235]
    ds_read_b128 v[48:51], v135 offset:448
    s_lshr_b32 s13, s4, 2
    s_add_u32 s12, s12, s13
    s_bfe_u32 s13, s4, 65537
    s_waitcnt lgkmcnt(12)
    v_mfma_f32_16x16x32_bf16 v[236:239], v[56:59], v[92:95], v[236:239]
    s_lshl_b32 s13, s13, 5
    s_add_u32 s12, s12, s13
    s_add_u32 s12, s12, 64
    s_waitcnt lgkmcnt(11)
    v_mfma_f32_16x16x32_bf16 v[240:243], v[60:63], v[92:95], v[240:243]
    s_lshl_b32 s12, s12, 7
    v_mov_b32 v8, s12
    v_cndmask_b32 v14, v8, v14, vcc
    s_waitcnt lgkmcnt(10)
    v_mfma_f32_16x16x32_bf16 v[244:247], v[64:67], v[92:95], v[244:247]
    s_waitcnt lgkmcnt(8)
    v_mfma_f32_16x16x32_bf16 v[232:235], v[20:23], v[96:99], v[232:235]
    s_waitcnt lgkmcnt(7)
    v_mfma_f32_16x16x32_bf16 v[236:239], v[24:27], v[96:99], v[236:239]
    v_mov_b32 v8, 163812
    s_add_u32 s55, s55, 4
    s_waitcnt lgkmcnt(0)
    s_mov_b64 exec, 1
    ds_add_u32 v8, v12
    s_mov_b64 exec, -1
    s_nop 0
    v_mfma_f32_16x16x32_bf16 v[240:243], v[28:31], v[96:99], v[240:243]
    v_mfma_f32_16x16x32_bf16 v[244:247], v[32:35], v[96:99], v[244:247]
    v_mfma_f32_16x16x32_bf16 v[232:235], v[36:39], v[100:103], v[232:235]
    v_mfma_f32_16x16x32_bf16 v[236:239], v[40:43], v[100:103], v[236:239]
    v_mfma_f32_16x16x32_bf16 v[240:243], v[44:47], v[100:103], v[240:243]
    v_mfma_f32_16x16x32_bf16 v[244:247], v[48:51], v[100:103], v[244:247]
    s_cmp_lt_u32 s7, 6
    s_cbranch_scc1 m_cons
    v_mov_b32 v8, 163812
m_lb2:
    ds_read_b32 v9, v8
    s_waitcnt lgkmcnt(0)
    v_readfirstlane_b32 s12, v9
    s_nop 0
    s_cmp_lt_u32 s12, s55
    s_cbranch_scc1 m_lb2
    s_cmp_lg_u32 s68, 0
    s_cbranch_scc1 m_kcopy0
    s_mov_b32 s68, 1
    v_mov_b32 v208, v232
    v_mov_b32 v209, v233
    v_mov_b32 v210, v234
    v_mov_b32 v211, v235
    v_mov_b32 v212, v236
    v_mov_b32 v213, v237
    v_mov_b32 v214, v238
    v_mov_b32 v215, v239
    v_mov_b32 v216, v240
    v_mov_b32 v217, v241
    v_mov_b32 v218, v242
    v_mov_b32 v219, v243
    v_mov_b32 v220, v244
    v_mov_b32 v221, v245
    v_mov_b32 v222, v246
    v_mov_b32 v223, v247
    s_branch m_tab
m_cons:
    s_lshr_b32 s12, s70, 1
    s_mul_i32 s14, s12, 16704
    s_sub_u32 s14, s14, s74
    s_and_b32 s13, s70, 1
    s_lshl_b32 s13, s13, 11
    s_sub_u32 s13, s14, s13
    s_add_u32 s13, s13, 123800
    v_lshlrev_b32 v8, 5, v3
    v_lshlrev_b32 v9, 3, v4
    v_sub_u32 v10, v9, v8
    v_add_u32 v10, s13, v10
    v_and_b32 v8, 1, v5
    v_mul_u32_u24 v8, 8316, v8
    v_add_u32 v112, v10, v8
    v_sub_u32 v113, v10, v8
    v_add_u32 v113, 8316, v113
    s_add_u32 s14, s14, 125368
    s_mul_i32 s15, s12, 4608
    s_add_u32 s15, s15, 154624
    s_sub_u32 s15, s15, s74
    v_mul_u32_u24 v10, 4160, v4
    v_and_b32 v9, 7, v3
    v_lshl_add_u32 v10, v9, 3, v10
    v_add_u32 v10, s14, v10
    v_min_u32 v9, 59, v1
    v_lshl_add_u32 v9, v9, 3, s15
    s_bitcmp0_b32 s70, 0
    s_cselect_b64 vcc, -1, 0
    v_cndmask_b32 v10, v9, v10, vcc
    v_cvt_pk_bf16_f32 v116, v232, v233
    v_cvt_pk_bf16_f32 v117, v234, v235
    v_cvt_pk_bf16_f32 v118, v233, v234
    v_cvt_pk_bf16_f32 v119, v236, v237
    v_cvt_pk_bf16_f32 v120, v238, v239
    v_cvt_pk_bf16_f32 v121, v237, v238
    v_cvt_pk_bf16_f32 v122, v240, v241
    v_cvt_pk_bf16_f32 v123, v242, v243
    v_cvt_pk_bf16_f32 v124, v241, v242
    v_cvt_pk_bf16_f32 v125, v244, v245
    v_cvt_pk_bf16_f32 v126, v246, v247
    v_cvt_pk_bf16_f32 v127, v245, v246
    v_mov_b32 v232, v116
    v_mov_b32 v233, v117
    v_mov_b32 v234, v118
    v_mov_b32 v235, v119
    v_mov_b32 v236, v120
    v_mov_b32 v237, v121
    v_mov_b32 v238, v122
    v_mov_b32 v239, v123
    v_mov_b32 v240, v124
    v_mov_b32 v241, v125
    v_mov_b32 v242, v126
    v_mov_b32 v243, v127
    v_mov_b32 v244, v112
    v_mov_b32 v245, v113
    v_mov_b32 v246, v10
    v_lshl_add_u32 v8, v4, 2, v5
    v_mul_u32_u24 v250, 352, v8
    s_mul_i32 s12, s70, 80
    s_add_u32 s12, s12, 0
    v_add_u32 v250, s12, v250
    v_lshl_add_u32 v250, v6, 3, v250
    v_mul_u32_u24 v251, 176, v8
    v_add_u32 v251, 88064, v251
    s_mul_i32 s12, s70, 40
    v_lshl_add_u32 v8, v6, 3, s12
    s_add_u32 s12, s12, 32
    v_mov_b32 v9, s12
    v_mov_b32 v10, 160
    v_cmp_eq_u32 vcc, 0, v6
    s_lshl_b32 s13, s69, 4
    s_sub_u32 s14, 16, s13
    v_cndmask_b32 v9, v10, v9, vcc
    s_cmp_lg_u32 s69, 0
    s_cselect_b64 vcc, -1, 0
    v_cndmask_b32 v8, v8, v9, vcc
    v_add_u32 v251, v251, v8
    s_max_u32 s14, s14, 5
    v_mul_u32_u24 v8, 21, v4
    v_cmp_gt_u32 vcc, s14, v3
    v_add3_u32 v8, v8, v3, s13
    v_lshlrev_b32 v8, 4, v8
    v_mov_b32 v9, 0x10000
    v_cndmask_b32 v252, v9, v8, vcc
    s_mov_b32 s15, 0
    v_mov_b32 v19, 45056
    s_barrier
    ds_read_b64_tr_b16 v[72:73], v230 offset:0
    ds_read_b64_tr_b16 v[74:75], v230 offset:1280
    ds_read_b128 v[92:95], v228 offset:0
    ds_read_b128 v[96:99], v228 offset:2048
    ds_read_b128 v[100:103], v228 offset:4096
    ds_read_b128 v[104:107], v228 offset:6144
    ds_read_b64_tr_b16 v[76:77], v231 offset:8
    ds_read_b64_tr_b16 v[78:79], v231 offset:1288
    ds_read_b64_tr_b16 v[80:81], v231 offset:16
    ds_read_b64_tr_b16 v[82:83], v231 offset:1296
    ds_read_b64_tr_b16 v[84:85], v231 offset:24
    ds_read_b64_tr_b16 v[86:87], v231 offset:1304
    ds_read_b64_tr_b16 v[88:89], v231 offset:32
    ds_read_b64_tr_b16 v[90:91], v231 offset:1312
    s_mov_b32 s65, 9
    s_waitcnt lgkmcnt(11)
    v_mfma_f32_16x16x32_bf16 v[144:147], v[72:75], v[92:95], 0
    ds_read_b64_tr_b16 v[108:109], v230 offset:10240
    s_waitcnt lgkmcnt(11)
    v_mfma_f32_16x16x32_bf16 v[164:167], v[72:75], v[96:99], 0
    ds_read_b64_tr_b16 v[110:111], v230 offset:11520
    s_waitcnt lgkmcnt(11)
    v_mfma_f32_16x16x32_bf16 v[184:187], v[72:75], v[100:103], 0
    ds_read_b128 v[128:131], v229 offset:0
    s_waitcnt lgkmcnt(11)
    v_mfma_f32_16x16x32_bf16 v[204:207], v[72:75], v[104:107], 0
    ds_read_b128 v[132:135], v229 offset:2048
    s_waitcnt lgkmcnt(10)
    v_mfma_f32_16x16x32_bf16 v[148:151], v[76:79], v[92:95], 0
    s_waitcnt vmcnt(4)
    ds_read_b128 v[136:139], v229 offset:4096
    v_mfma_f32_16x16x32_bf16 v[168:171], v[76:79], v[96:99], 0
    s_waitcnt vmcnt(0)
    ds_read_b128 v[140:143], v229 offset:6144
    v_mfma_f32_16x16x32_bf16 v[188:191], v[76:79], v[100:103], 0
    ds_read_b64_tr_b16 v[112:113], v231 offset:10248
    v_mfma_f32_16x16x32_bf16 v[208:211], v[76:79], v[104:107], 0
    ds_read_b64_tr_b16 v[114:115], v231 offset:11528
    s_waitcnt lgkmcnt(12)
    v_mfma_f32_16x16x32_bf16 v[152:155], v[80:83], v[92:95], 0
    ds_read_b64_tr_b16 v[116:117], v231 offset:10256
    v_mfma_f32_16x16x32_bf16 v[172:175], v[80:83], v[96:99], 0
    ds_read_b64_tr_b16 v[118:119], v231 offset:11536
    v_mfma_f32_16x16x32_bf16 v[192:195], v[80:83], v[100:103], 0
    ds_read_b64_tr_b16 v[120:121], v231 offset:10264
    v_mfma_f32_16x16x32_bf16 v[212:215], v[80:83], v[104:107], 0
    ds_read_b64_tr_b16 v[122:123], v231 offset:11544
    s_waitcnt lgkmcnt(14)
    v_mfma_f32_16x16x32_bf16 v[156:159], v[84:87], v[92:95], 0
    ds_read_b64_tr_b16 v[124:125], v231 offset:10272
    v_mfma_f32_16x16x32_bf16 v[176:179], v[84:87], v[96:99], 0
    ds_read_b64_tr_b16 v[126:127], v231 offset:11552
    v_mfma_f32_16x16x32_bf16 v[196:199], v[84:87], v[100:103], 0
    s_add_u32 s15, s15, 36864
    s_cmp_ge_u32 s15, 110592
    s_cselect_b32 s15, 0, s15
    v_mfma_f32_16x16x32_bf16 v[216:219], v[84:87], v[104:107], 0
    v_add_u32 v228, s15, v224
    s_waitcnt lgkmcnt(14)
    v_mfma_f32_16x16x32_bf16 v[160:163], v[88:91], v[92:95], 0
    v_add_u32 v229, s15, v225
    v_mfma_f32_16x16x32_bf16 v[180:183], v[88:91], v[96:99], 0
    v_add_u32 v230, s15, v226
    v_mfma_f32_16x16x32_bf16 v[200:203], v[88:91], v[100:103], 0
    v_add_u32 v231, s15, v227
    v_mfma_f32_16x16x32_bf16 v[220:223], v[88:91], v[104:107], 0
    s_branch m_loop_f
m_loop:
    s_waitcnt lgkmcnt(0)
    v_mfma_f32_16x16x32_bf16 v[144:147], v[72:75], v[92:95], v[144:147]
    ds_read_b64_tr_b16 v[108:109], v230 offset:10240
    v_mfma_f32_16x16x32_bf16 v[164:167], v[72:75], v[96:99], v[164:167]
    ds_read_b64_tr_b16 v[110:111], v230 offset:11520
    v_mfma_f32_16x16x32_bf16 v[184:187], v[72:75], v[100:103], v[184:187]
    ds_read_b128 v[128:131], v229 offset:0
    v_mfma_f32_16x16x32_bf16 v[204:207], v[72:75], v[104:107], v[204:207]
    ds_read_b128 v[132:135], v229 offset:2048
    v_mfma_f32_16x16x32_bf16 v[148:151], v[76:79], v[92:95], v[148:151]
    ds_read_b128 v[136:139], v229 offset:4096
    v_mfma_f32_16x16x32_bf16 v[168:171], v[76:79], v[96:99], v[168:171]
    ds_read_b128 v[140:143], v229 offset:6144
    v_mfma_f32_16x16x32_bf16 v[188:191], v[76:79], v[100:103], v[188:191]
    ds_read_b64_tr_b16 v[112:113], v231 offset:10248
    v_mfma_f32_16x16x32_bf16 v[208:211], v[76:79], v[104:107], v[208:211]
    ds_read_b64_tr_b16 v[114:115], v231 offset:11528
    v_mfma_f32_16x16x32_bf16 v[152:155], v[80:83], v[92:95], v[152:155]
    ds_read_b64_tr_b16 v[116:117], v231 offset:10256
    v_mfma_f32_16x16x32_bf16 v[172:175], v[80:83], v[96:99], v[172:175]
    ds_read_b64_tr_b16 v[118:119], v231 offset:11536
    v_mfma_f32_16x16x32_bf16 v[192:195], v[80:83], v[100:103], v[192:195]
    ds_read_b64_tr_b16 v[120:121], v231 offset:10264
    v_mfma_f32_16x16x32_bf16 v[212:215], v[80:83], v[104:107], v[212:215]
    ds_read_b64_tr_b16 v[122:123], v231 offset:11544
    v_mfma_f32_16x16x32_bf16 v[156:159], v[84:87], v[92:95], v[156:159]
    ds_read_b64_tr_b16 v[124:125], v231 offset:10272
    v_mfma_f32_16x16x32_bf16 v[176:179], v[84:87], v[96:99], v[176:179]
    ds_read_b64_tr_b16 v[126:127], v231 offset:11552
    v_mfma_f32_16x16x32_bf16 v[196:199], v[84:87], v[100:103], v[196:199]
    s_add_u32 s15, s15, 36864
    s_cmp_ge_u32 s15, 110592
    s_cselect_b32 s15, 0, s15
    v_mfma_f32_16x16x32_bf16 v[216:219], v[84:87], v[104:107], v[216:219]
    v_add_u32 v228, s15, v224
    v_mfma_f32_16x16x32_bf16 v[160:163], v[88:91], v[92:95], v[160:163]
    v_add_u32 v229, s15, v225
    v_mfma_f32_16x16x32_bf16 v[180:183], v[88:91], v[96:99], v[180:183]
    v_add_u32 v230, s15, v226
    v_mfma_f32_16x16x32_bf16 v[200:203], v[88:91], v[100:103], v[200:203]
    v_add_u32 v231, s15, v227
    v_mfma_f32_16x16x32_bf16 v[220:223], v[88:91], v[104:107], v[220:223]
m_loop_f:
    s_waitcnt lgkmcnt(0)
    s_barrier
    v_mfma_f32_16x16x32_bf16 v[144:147], v[108:111], v[128:131], v[144:147]
    ds_read_b64_tr_b16 v[72:73], v230 offset:0
    v_mfma_f32_16x16x32_bf16 v[164:167], v[108:111], v[132:135], v[164:167]
    ds_read_b64_tr_b16 v[74:75], v230 offset:1280
    v_mfma_f32_16x16x32_bf16 v[184:187], v[108:111], v[136:139], v[184:187]
    ds_read_b128 v[92:95], v228 offset:0
    v_mfma_f32_16x16x32_bf16 v[204:207], v[108:111], v[140:143], v[204:207]
    ds_read_b128 v[96:99], v228 offset:2048
    v_mfma_f32_16x16x32_bf16 v[148:151], v[112:115], v[128:131], v[148:151]
    ds_read_b128 v[100:103], v228 offset:4096
    v_mfma_f32_16x16x32_bf16 v[168:171], v[112:115], v[132:135], v[168:171]
    ds_read_b128 v[104:107], v228 offset:6144
    v_mfma_f32_16x16x32_bf16 v[188:191], v[112:115], v[136:139], v[188:191]
    ds_read_b64_tr_b16 v[76:77], v231 offset:8
    v_mfma_f32_16x16x32_bf16 v[208:211], v[112:115], v[140:143], v[208:211]
    ds_read_b64_tr_b16 v[78:79], v231 offset:1288
    v_mfma_f32_16x16x32_bf16 v[152:155], v[116:119], v[128:131], v[152:155]
    ds_read_b64_tr_b16 v[80:81], v231 offset:16
    v_mfma_f32_16x16x32_bf16 v[172:175], v[116:119], v[132:135], v[172:175]
    ds_read_b64_tr_b16 v[82:83], v231 offset:1296
    v_mfma_f32_16x16x32_bf16 v[192:195], v[116:119], v[136:139], v[192:195]
    ds_read_b64_tr_b16 v[84:85], v231 offset:24
    v_mfma_f32_16x16x32_bf16 v[212:215], v[116:119], v[140:143], v[212:215]
    ds_read_b64_tr_b16 v[86:87], v231 offset:1304
    v_mfma_f32_16x16x32_bf16 v[156:159], v[120:123], v[128:131], v[156:159]
    ds_read_b64_tr_b16 v[88:89], v231 offset:32
    v_mfma_f32_16x16x32_bf16 v[176:179], v[120:123], v[132:135], v[176:179]
    ds_read_b64_tr_b16 v[90:91], v231 offset:1312
    v_mfma_f32_16x16x32_bf16 v[196:199], v[120:123], v[136:139], v[196:199]
    s_sub_u32 s65, s65, 1
    s_cmp_lg_u32 s65, 0
    v_mfma_f32_16x16x32_bf16 v[216:219], v[120:123], v[140:143], v[216:219]
    v_mfma_f32_16x16x32_bf16 v[160:163], v[124:127], v[128:131], v[160:163]
    v_mfma_f32_16x16x32_bf16 v[180:183], v[124:127], v[132:135], v[180:183]
    v_mfma_f32_16x16x32_bf16 v[200:203], v[124:127], v[136:139], v[200:203]
    v_mfma_f32_16x16x32_bf16 v[220:223], v[124:127], v[140:143], v[220:223]
    s_cbranch_scc1 m_loop
    s_waitcnt lgkmcnt(0)
    v_mfma_f32_16x16x32_bf16 v[144:147], v[72:75], v[92:95], v[144:147]
    ds_read_b64_tr_b16 v[108:109], v230 offset:10240
    v_mfma_f32_16x16x32_bf16 v[164:167], v[72:75], v[96:99], v[164:167]
    ds_read_b64_tr_b16 v[110:111], v230 offset:11520
    v_mfma_f32_16x16x32_bf16 v[184:187], v[72:75], v[100:103], v[184:187]
    ds_read_b128 v[128:131], v229 offset:0
    v_mfma_f32_16x16x32_bf16 v[204:207], v[72:75], v[104:107], v[204:207]
    ds_read_b128 v[132:135], v229 offset:2048
    v_mfma_f32_16x16x32_bf16 v[148:151], v[76:79], v[92:95], v[148:151]
    ds_read_b128 v[136:139], v229 offset:4096
    v_mfma_f32_16x16x32_bf16 v[168:171], v[76:79], v[96:99], v[168:171]
    ds_read_b128 v[140:143], v229 offset:6144
    v_mfma_f32_16x16x32_bf16 v[188:191], v[76:79], v[100:103], v[188:191]
    ds_read_b64_tr_b16 v[112:113], v231 offset:10248
    v_mfma_f32_16x16x32_bf16 v[208:211], v[76:79], v[104:107], v[208:211]
    ds_read_b64_tr_b16 v[114:115], v231 offset:11528
    v_mfma_f32_16x16x32_bf16 v[152:155], v[80:83], v[92:95], v[152:155]
    ds_read_b64_tr_b16 v[116:117], v231 offset:10256
    v_mfma_f32_16x16x32_bf16 v[172:175], v[80:83], v[96:99], v[172:175]
    ds_read_b64_tr_b16 v[118:119], v231 offset:11536
    v_mfma_f32_16x16x32_bf16 v[192:195], v[80:83], v[100:103], v[192:195]
    ds_read_b64_tr_b16 v[120:121], v231 offset:10264
    v_mfma_f32_16x16x32_bf16 v[212:215], v[80:83], v[104:107], v[212:215]
    ds_read_b64_tr_b16 v[122:123], v231 offset:11544
    v_mfma_f32_16x16x32_bf16 v[156:159], v[84:87], v[92:95], v[156:159]
    ds_read_b64_tr_b16 v[124:125], v231 offset:10272
    v_mfma_f32_16x16x32_bf16 v[176:179], v[84:87], v[96:99], v[176:179]
    ds_read_b64_tr_b16 v[126:127], v231 offset:11552
    v_mfma_f32_16x16x32_bf16 v[196:199], v[84:87], v[100:103], v[196:199]
    ds_read_b64_tr_b16 v[20:21], v16 offset:0
    v_mfma_f32_16x16x32_bf16 v[216:219], v[84:87], v[104:107], v[216:219]
    ds_read_b64_tr_b16 v[22:23], v16 offset:160
    v_mfma_f32_16x16x32_bf16 v[160:163], v[88:91], v[92:95], v[160:163]
    ds_read_b64_tr_b16 v[24:25], v16 offset:320
    v_mfma_f32_16x16x32_bf16 v[180:183], v[88:91], v[96:99], v[180:183]
    ds_read_b64_tr_b16 v[26:27], v16 offset:480
    v_mfma_f32_16x16x32_bf16 v[200:203], v[88:91], v[100:103], v[200:203]
    ds_read_b64_tr_b16 v[28:29], v16 offset:640
    v_mfma_f32_16x16x32_bf16 v[220:223], v[88:91], v[104:107], v[220:223]
    ds_read_b64_tr_b16 v[30:31], v16 offset:8
    s_waitcnt lgkmcnt(14)
    v_mfma_f32_16x16x32_bf16 v[144:147], v[108:111], v[128:131], v[144:147]
    ds_read_b64_tr_b16 v[32:33], v16 offset:168
    v_mfma_f32_16x16x32_bf16 v[164:167], v[108:111], v[132:135], v[164:167]
    ds_read_b64_tr_b16 v[34:35], v16 offset:328
    v_mfma_f32_16x16x32_bf16 v[184:187], v[108:111], v[136:139], v[184:187]
    ds_read_b64_tr_b16 v[36:37], v16 offset:488
    v_mfma_f32_16x16x32_bf16 v[204:207], v[108:111], v[140:143], v[204:207]
    ds_read_b64_tr_b16 v[38:39], v16 offset:648
    s_waitcnt lgkmcnt(14)
    v_mfma_f32_16x16x32_bf16 v[148:151], v[112:115], v[128:131], v[148:151]
    ds_read_b64_tr_b16 v[40:41], v16 offset:16
    v_mfma_f32_16x16x32_bf16 v[168:171], v[112:115], v[132:135], v[168:171]
    ds_read_b64_tr_b16 v[42:43], v16 offset:176
    v_mfma_f32_16x16x32_bf16 v[188:191], v[112:115], v[136:139], v[188:191]
    ds_read_b64_tr_b16 v[44:45], v16 offset:336
    v_mfma_f32_16x16x32_bf16 v[208:211], v[112:115], v[140:143], v[208:211]
    ds_read_b64_tr_b16 v[46:47], v16 offset:496
    v_mfma_f32_16x16x32_bf16 v[152:155], v[116:119], v[128:131], v[152:155]
    ds_read_b64_tr_b16 v[48:49], v16 offset:656
    v_mfma_f32_16x16x32_bf16 v[172:175], v[116:119], v[132:135], v[172:175]
    ds_read_b64_tr_b16 v[50:51], v16 offset:24
    v_mfma_f32_16x16x32_bf16 v[192:195], v[116:119], v[136:139], v[192:195]
    ds_read_b64_tr_b16 v[52:53], v16 offset:184
    v_mfma_f32_16x16x32_bf16 v[212:215], v[116:119], v[140:143], v[212:215]
    ds_read_b64_tr_b16 v[54:55], v16 offset:344
    s_waitcnt lgkmcnt(14)
    v_mfma_f32_16x16x32_bf16 v[156:159], v[120:123], v[128:131], v[156:159]
    ds_read_b64_tr_b16 v[56:57], v16 offset:504
    v_mfma_f32_16x16x32_bf16 v[176:179], v[120:123], v[132:135], v[176:179]
    ds_read_b64_tr_b16 v[58:59], v16 offset:664
    v_mfma_f32_16x16x32_bf16 v[196:199], v[120:123], v[136:139], v[196:199]
    ds_read_b64_tr_b16 v[60:61], v16 offset:32
    v_mfma_f32_16x16x32_bf16 v[216:219], v[120:123], v[140:143], v[216:219]
    ds_read_b64_tr_b16 v[62:63], v16 offset:192
    v_mfma_f32_16x16x32_bf16 v[160:163], v[124:127], v[128:131], v[160:163]
    ds_read_b64_tr_b16 v[64:65], v16 offset:352
    v_mfma_f32_16x16x32_bf16 v[180:183], v[124:127], v[132:135], v[180:183]
    ds_read_b64_tr_b16 v[66:67], v16 offset:512
    v_mfma_f32_16x16x32_bf16 v[200:203], v[124:127], v[136:139], v[200:203]
    ds_read_b64_tr_b16 v[68:69], v16 offset:672
    v_mfma_f32_16x16x32_bf16 v[220:223], v[124:127], v[140:143], v[220:223]
    s_cmp_lt_u32 s7, 4
    s_cbranch_scc1 m_c_kv
    s_mov_b32 s12, 81920
    v_mul_lo_u32 v8, v4, s12
    v_lshl_add_u32 v17, v3, 4, v8
    v_lshl_add_u32 v18, v3, 3, v8
    s_lshr_b32 s13, s70, 1
    s_lshl_b32 s13, s13, 2
    s_add_u32 s13, s13, s8
    s_mul_i32 s13, s13, 81920
    s_lshl_b32 s14, s6, 1
    s_and_b32 s15, s70, 1
    s_add_u32 s14, s14, s15
    s_mul_i32 s14, s14, 2560
    s_add_u32 s13, s13, s14
    s_add_u32 s52, s46, 0
    s_addc_u32 s53, s47, 0
    s_add_u32 s52, s52, s13
    s_addc_u32 s53, s53, 0
    s_mov_b32 s54, 327680
    s_mov_b32 s55, 0x20000
    v_cvt_pk_bf16_f32 v72, v144, v145
    v_cvt_pk_bf16_f32 v73, v146, v147
    v_cvt_pk_bf16_f32 v74, v148, v149
    v_cvt_pk_bf16_f32 v75, v150, v151
    v_cvt_pk_bf16_f32 v76, v152, v153
    v_cvt_pk_bf16_f32 v77, v154, v155
    v_cvt_pk_bf16_f32 v78, v156, v157
    v_cvt_pk_bf16_f32 v79, v158, v159
    v_cvt_pk_bf16_f32 v80, v160, v161
    v_cvt_pk_bf16_f32 v81, v162, v163
    buffer_store_dwordx4 v[72:75], v17, s[52:55], 0 offen offset:0 sc1
    buffer_store_dwordx4 v[76:79], v17, s[52:55], 0 offen offset:256 sc1
    buffer_store_dwordx2 v[80:81], v18, s[52:55], 0 offen offset:512 sc1
    v_cvt_pk_bf16_f32 v84, v164, v165
    v_cvt_pk_bf16_f32 v85, v166, v167
    v_cvt_pk_bf16_f32 v86, v168, v169
    v_cvt_pk_bf16_f32 v87, v170, v171
    v_cvt_pk_bf16_f32 v88, v172, v173
    v_cvt_pk_bf16_f32 v89, v174, v175
    v_cvt_pk_bf16_f32 v90, v176, v177
    v_cvt_pk_bf16_f32 v91, v178, v179
    v_cvt_pk_bf16_f32 v92, v180, v181
    v_cvt_pk_bf16_f32 v93, v182, v183
    buffer_store_dwordx4 v[84:87], v17, s[52:55], 0 offen offset:640 sc1
    buffer_store_dwordx4 v[88:91], v17, s[52:55], 0 offen offset:896 sc1
    buffer_store_dwordx2 v[92:93], v18, s[52:55], 0 offen offset:1152 sc1
    v_cvt_pk_bf16_f32 v96, v184, v185
    v_cvt_pk_bf16_f32 v97, v186, v187
    v_cvt_pk_bf16_f32 v98, v188, v189
    v_cvt_pk_bf16_f32 v99, v190, v191
    v_cvt_pk_bf16_f32 v100, v192, v193
    v_cvt_pk_bf16_f32 v101, v194, v195
    v_cvt_pk_bf16_f32 v102, v196, v197
    v_cvt_pk_bf16_f32 v103, v198, v199
    v_cvt_pk_bf16_f32 v104, v200, v201
    v_cvt_pk_bf16_f32 v105, v202, v203
    buffer_store_dwordx4 v[96:99], v17, s[52:55], 0 offen offset:1280 sc1
    buffer_store_dwordx4 v[100:103], v17, s[52:55], 0 offen offset:1536 sc1
    buffer_store_dwordx2 v[104:105], v18, s[52:55], 0 offen offset:1792 sc1
    v_cvt_pk_bf16_f32 v108, v204, v205
    v_cvt_pk_bf16_f32 v109, v206, v207
    v_cvt_pk_bf16_f32 v110, v208, v209
    v_cvt_pk_bf16_f32 v111, v210, v211
    v_cvt_pk_bf16_f32 v112, v212, v213
    v_cvt_pk_bf16_f32 v113, v214, v215
    v_cvt_pk_bf16_f32 v114, v216, v217
    v_cvt_pk_bf16_f32 v115, v218, v219
    v_cvt_pk_bf16_f32 v116, v220, v221
    v_cvt_pk_bf16_f32 v117, v222, v223
    buffer_store_dwordx4 v[108:111], v17, s[52:55], 0 offen offset:1920 sc1
    buffer_store_dwordx4 v[112:115], v17, s[52:55], 0 offen offset:2176 sc1
    buffer_store_dwordx2 v[116:117], v18, s[52:55], 0 offen offset:2432 sc1
    s_sub_u32 s72, s2, 64
    s_barrier
    s_branch m_kcopy
m_c_kv:
    s_and_b32 s9, s70, 1
    s_mul_i32 s12, s9, 12288
    v_add3_u32 v10, s12, v7, v19
    s_lshl_b32 s9, s9, 2
    s_cmp_ge_u32 s70, 2
    s_cbranch_scc1 m_c_v
    v_cvt_pk_bf16_f32 v96, v184, v185
    v_cvt_pk_bf16_f32 v97, v186, v187
    v_cvt_pk_bf16_f32 v98, v188, v189
    v_cvt_pk_bf16_f32 v99, v190, v191
    v_cvt_pk_bf16_f32 v100, v192, v193
    v_cvt_pk_bf16_f32 v101, v194, v195
    v_cvt_pk_bf16_f32 v102, v196, v197
    v_cvt_pk_bf16_f32 v103, v198, v199
    v_cvt_pk_bf16_f32 v104, v200, v201
    v_cvt_pk_bf16_f32 v105, v202, v203
    ds_write_b128 v10, v[96:99] offset:3072
    ds_write_b128 v10, v[100:103] offset:4096
    ds_write_b64 v10, v[104:105] offset:5120
    v_cvt_pk_bf16_f32 v108, v204, v205
    v_cvt_pk_bf16_f32 v109, v206, v207
    v_cvt_pk_bf16_f32 v110, v208, v209
    v_cvt_pk_bf16_f32 v111, v210, v211
    v_cvt_pk_bf16_f32 v112, v212, v213
    v_cvt_pk_bf16_f32 v113, v214, v215
    v_cvt_pk_bf16_f32 v114, v216, v217
    v_cvt_pk_bf16_f32 v115, v218, v219
    v_cvt_pk_bf16_f32 v116, v220, v221
    v_cvt_pk_bf16_f32 v117, v222, v223
    ds_write_b128 v10, v[108:111] offset:6144
    ds_write_b128 v10, v[112:115] offset:7168
    ds_write_b64 v10, v[116:117] offset:8192
    v_cvt_pk_bf16_f32 v84, v164, v165
    v_cvt_pk_bf16_f32 v85, v166, v167
    v_cvt_pk_bf16_f32 v86, v168, v169
    v_cvt_pk_bf16_f32 v87, v170, v171
    v_cvt_pk_bf16_f32 v88, v172, v173
    v_cvt_pk_bf16_f32 v89, v174, v175
    v_cvt_pk_bf16_f32 v90, v176, v177
    v_cvt_pk_bf16_f32 v91, v178, v179
    v_cvt_pk_bf16_f32 v92, v180, v181
    v_cvt_pk_bf16_f32 v93, v182, v183
    ds_write_b128 v10, v[84:87] offset:0
    ds_write_b128 v10, v[88:91] offset:1024
    ds_write_b64 v10, v[92:93] offset:2048
    v_cvt_pk_bf16_f32 v72, v144, v145
    v_cvt_pk_bf16_f32 v73, v146, v147
    v_cvt_pk_bf16_f32 v74, v148, v149
    v_cvt_pk_bf16_f32 v75, v150, v151
    v_cvt_pk_bf16_f32 v76, v152, v153
    v_cvt_pk_bf16_f32 v77, v154, v155
    v_cvt_pk_bf16_f32 v78, v156, v157
    v_cvt_pk_bf16_f32 v79, v158, v159
    v_cvt_pk_bf16_f32 v80, v160, v161
    v_cvt_pk_bf16_f32 v81, v162, v163
    s_waitcnt vmcnt(0) lgkmcnt(0)
    s_barrier
    s_branch m_unit0
m_c_v:
    s_lshl_b32 s12, s9, 4
    v_add_u32 v8, s12, v3
    v_mul_u32_u24 v18, 176, v8
    v_add_u32 v18, 88064, v18
    v_mul_u32_u24 v8, 40, v4
    v_add_u32 v8, v18, v8
    v_mov_b32 v124, 0x3f803f80
    v_mov_b32 v125, 0x3f803f80
    s_add_u32 s9, s9, 1
    v_cvt_pk_bf16_f32 v84, v144, v145
    v_cvt_pk_bf16_f32 v85, v146, v147
    v_cvt_pk_bf16_f32 v86, v148, v149
    v_cvt_pk_bf16_f32 v87, v150, v151
    v_cvt_pk_bf16_f32 v88, v152, v153
    v_cvt_pk_bf16_f32 v89, v154, v155
    v_cvt_pk_bf16_f32 v90, v156, v157
    v_cvt_pk_bf16_f32 v91, v158, v159
    v_cvt_pk_bf16_f32 v92, v160, v161
    v_cvt_pk_bf16_f32 v93, v162, v163
    v_cvt_pk_bf16_f32 v94, v164, v165
    v_cvt_pk_bf16_f32 v95, v166, v167
    v_cvt_pk_bf16_f32 v96, v168, v169
    v_cvt_pk_bf16_f32 v97, v170, v171
    v_cvt_pk_bf16_f32 v98, v172, v173
    v_cvt_pk_bf16_f32 v99, v174, v175
    v_cvt_pk_bf16_f32 v100, v176, v177
    v_cvt_pk_bf16_f32 v101, v178, v179
    v_cvt_pk_bf16_f32 v102, v180, v181
    v_cvt_pk_bf16_f32 v103, v182, v183
    v_cvt_pk_bf16_f32 v104, v184, v185
    v_cvt_pk_bf16_f32 v105, v186, v187
    v_cvt_pk_bf16_f32 v106, v188, v189
    v_cvt_pk_bf16_f32 v107, v190, v191
    v_cvt_pk_bf16_f32 v108, v192, v193
    v_cvt_pk_bf16_f32 v109, v194, v195
    v_cvt_pk_bf16_f32 v110, v196, v197
    v_cvt_pk_bf16_f32 v111, v198, v199
    v_cvt_pk_bf16_f32 v112, v200, v201
    v_cvt_pk_bf16_f32 v113, v202, v203
    v_cvt_pk_bf16_f32 v114, v204, v205
    v_cvt_pk_bf16_f32 v115, v206, v207
    v_cvt_pk_bf16_f32 v116, v208, v209
    v_cvt_pk_bf16_f32 v117, v210, v211
    v_cvt_pk_bf16_f32 v118, v212, v213
    v_cvt_pk_bf16_f32 v119, v214, v215
    v_cvt_pk_bf16_f32 v120, v216, v217
    v_cvt_pk_bf16_f32 v121, v218, v219
    v_cvt_pk_bf16_f32 v122, v220, v221
    v_cvt_pk_bf16_f32 v123, v222, v223
    s_waitcnt lgkmcnt(0)
    s_barrier
    ds_read_b128 v[72:75], v10 offset:0
    ds_read_b128 v[76:79], v10 offset:1024
    ds_read_b64 v[80:81], v10 offset:2048
    ds_write_b64 v8, v[84:85] offset:0
    ds_write_b64 v8, v[86:87] offset:8
    ds_write_b64 v8, v[88:89] offset:16
    ds_write_b64 v8, v[90:91] offset:24
    ds_write_b64 v8, v[92:93] offset:32
    ds_write_b64 v18, v[124:125] offset:160
    ds_write_b64 v8, v[94:95] offset:2816
    ds_write_b64 v8, v[96:97] offset:2824
    ds_write_b64 v8, v[98:99] offset:2832
    ds_write_b64 v8, v[100:101] offset:2840
    ds_write_b64 v8, v[102:103] offset:2848
    ds_write_b64 v18, v[124:125] offset:2976
    ds_write_b64 v8, v[104:105] offset:5632
    ds_write_b64 v8, v[106:107] offset:5640
    ds_write_b64 v8, v[108:109] offset:5648
    ds_write_b64 v8, v[110:111] offset:5656
    ds_write_b64 v8, v[112:113] offset:5664
    ds_write_b64 v18, v[124:125] offset:5792
    ds_write_b64 v8, v[114:115] offset:8448
    ds_write_b64 v8, v[116:117] offset:8456
    ds_write_b64 v8, v[118:119] offset:8464
    ds_write_b64 v8, v[120:121] offset:8472
    ds_write_b64 v8, v[122:123] offset:8480
    ds_write_b64 v18, v[124:125] offset:8608
    s_branch m_unit0
m_hi:
    s_cmp_ge_u32 s7, 6
    s_cbranch_scc1 m_phi0
    s_cmp_lt_u32 s7, 4
    s_cselect_b32 s9, 1280, 0
    s_cselect_b32 s10, 1120, 0
    s_mov_b32 s15, 3200
    s_mul_i32 s12, s8, 40
    s_add_u32 s9, s9, s12
    s_and_b32 s13, s5, 3
    s_mul_i32 s13, s13, 5
    s_mul_i32 s14, s7, 6
    s_add_u32 s13, s13, s14
    s_mul_i32 s14, s4, 2
    s_add_u32 s13, s13, s14
    s_lshr_b32 s13, s13, 1
    s_mul_i32 s14, s13, 6554
    s_lshr_b32 s14, s14, 16
    s_mul_i32 s73, s14, 10
    s_sub_u32 s73, s13, s73
    s_lshl_b32 s12, s6, 7
    s_lshl_b32 s13, s70, 5
    s_add_u32 s12, s12, s13
    v_lshrrev_b32 v8, 3, v1
    v_add_u32 v8, s12, v8
    v_mul_u32_u24 v8, 1280, v8
    v_and_b32 v9, 7, v1
    v_xor_b32 v9, v9, v4
    v_lshl_add_u32 v240, v9, 4, v8
    v_xor_b32 v9, 4, v9
    v_lshl_add_u32 v241, v9, 4, v8
    v_add_u32 v241, 10240, v241
    v_add_u32 v242, 20480, v240
    v_add_u32 v243, 20480, v241
    s_mul_i32 s14, s70, 61440
    s_add_u32 s14, s14, s9
    s_lshl_b32 s9, s70, 12
    s_lshl_b32 s12, s73, 7
    s_waitcnt lgkmcnt(0)
    s_barrier
    s_mov_b32 s48, s16
    s_mov_b32 s49, s17
    s_mov_b32 s50, 2621440
    s_mov_b32 s51, 0x20000
    s_add_u32 m0, s9, 0
    s_nop 0
    buffer_load_dwordx4 v240, s[48:51], s12 offen lds
    s_add_u32 m0, s9, 1024
    s_nop 0
    buffer_load_dwordx4 v241, s[48:51], s12 offen lds
    s_add_u32 m0, s9, 2048
    s_nop 0
    buffer_load_dwordx4 v242, s[48:51], s12 offen lds
    s_add_u32 m0, s9, 3072
    s_nop 0
    buffer_load_dwordx4 v243, s[48:51], s12 offen lds
    s_mov_b32 s52, s18
    s_mov_b32 s53, s19
    s_mov_b32 s54, 2457600
    s_mov_b32 s55, 0x20000
    s_mul_i32 s13, s73, 245760
    s_mul_i32 s65, s70, 5120
    s_add_u32 s65, s65, 16384
    v_add_u32 v8, 0, v1
    v_mul_u32_u24 v9, 3277, v8
    v_lshrrev_b32 v9, 16, v9
    v_mul_u32_u24 v10, 20, v9
    v_sub_u32 v10, v8, v10
    v_mul_u32_u24 v9, 3840, v9
    v_cmp_le_u32 vcc, 10, v10
    v_lshl_add_u32 v9, v10, 4, v9
    v_add_u32 v9, s14, v9
    v_add_u32 v8, s10, v9
    s_add_u32 m0, s65, 0
    v_cndmask_b32 v244, v9, v8, vcc
    buffer_load_dwordx4 v244, s[52:55], s13 offen lds
    v_add_u32 v8, 64, v1
    v_mul_u32_u24 v9, 3277, v8
    v_lshrrev_b32 v9, 16, v9
    v_mul_u32_u24 v10, 20, v9
    v_sub_u32 v10, v8, v10
    v_mul_u32_u24 v9, 3840, v9
    v_cmp_le_u32 vcc, 10, v10
    v_lshl_add_u32 v9, v10, 4, v9
    v_add_u32 v9, s14, v9
    v_add_u32 v8, s10, v9
    s_add_u32 m0, s65, 1024
    v_cndmask_b32 v245, v9, v8, vcc
    buffer_load_dwordx4 v245, s[52:55], s13 offen lds
    v_add_u32 v8, 128, v1
    v_mul_u32_u24 v9, 3277, v8
    v_lshrrev_b32 v9, 16, v9
    v_mul_u32_u24 v10, 20, v9
    v_sub_u32 v10, v8, v10
    v_lshrrev_b32 v8, 3, v9
    v_lshlrev_b32 v8, 1, v8
    v_sub_u32 v10, v10, v8
    v_add_u32 v8, 20, v10
    v_min_u32 v10, v10, v8
    v_mul_u32_u24 v9, 3840, v9
    v_cmp_le_u32 vcc, 10, v10
    v_lshl_add_u32 v9, v10, 4, v9
    v_add_u32 v9, s14, v9
    v_add_u32 v8, s10, v9
    s_add_u32 m0, s65, 2048
    v_cndmask_b32 v246, v9, v8, vcc
    buffer_load_dwordx4 v246, s[52:55], s13 offen lds
    v_add_u32 v8, 192, v1
    v_mul_u32_u24 v9, 3277, v8
    v_lshrrev_b32 v9, 16, v9
    v_mul_u32_u24 v10, 20, v9
    v_sub_u32 v10, v8, v10
    v_subrev_u32 v10, 2, v10
    v_add_u32 v8, 20, v10
    v_min_u32 v10, v10, v8
    v_mul_u32_u24 v9, 3840, v9
    v_cmp_le_u32 vcc, 10, v10
    v_lshl_add_u32 v9, v10, 4, v9
    v_add_u32 v9, s14, v9
    v_add_u32 v8, s10, v9
    s_add_u32 m0, s65, 3072
    v_cndmask_b32 v247, v9, v8, vcc
    buffer_load_dwordx4 v247, s[52:55], s13 offen lds
    v_add_u32 v8, 256, v1
    v_mul_u32_u24 v9, 3277, v8
    v_lshrrev_b32 v9, 16, v9
    v_mul_u32_u24 v10, 20, v9
    v_sub_u32 v10, v8, v10
    v_subrev_u32 v10, 2, v10
    v_add_u32 v8, 20, v10
    v_min_u32 v10, v10, v8
    v_mul_u32_u24 v9, 3840, v9
    v_cmp_le_u32 vcc, 10, v10
    v_lshl_add_u32 v9, v10, 4, v9
    v_add_u32 v9, s14, v9
    v_add_u32 v8, s10, v9
    s_add_u32 m0, s65, 4096
    v_cndmask_b32 v248, v9, v8, vcc
    buffer_load_dwordx4 v248, s[52:55], s13 offen lds
    s_mov_b32 s10, s65
    s_mul_i32 s12, s8, 800
    s_add_u32 s60, s20, s12
    s_addc_u32 s61, s21, 0
    s_mov_b32 s62, s15
    s_mov_b32 s63, 0x20000
    s_lshl_b32 s12, s70, 10
    v_add_u32 v8, s12, v7
    s_add_u32 m0, s12, 147456
    s_nop 0
    buffer_load_dwordx4 v8, s[60:63], 0 offen lds
    s_add_u32 s73, s73, 1
    s_cmp_eq_u32 s73, 10
    s_cselect_b32 s73, 0, s73
    s_add_u32 s9, s9, 36864
    s_add_u32 s10, s10, 36864
    s_cmp_ge_u32 s9, 110592
    s_cselect_b32 s12, 110592, 0
    s_sub_u32 s9, s9, s12
    s_sub_u32 s10, s10, s12
    s_branch m_load
m_phi0:
    s_mul_i32 s54, s70, 10240
    s_mul_i32 s9, s6, 5
    s_add_u32 s9, s9, s70
    v_lshrrev_b32 v9, 3, v1
    v_mul_u32_u24 v9, 1280, v9
    v_and_b32 v8, 7, v1
    v_lshl_add_u32 v9, v8, 4, v9
    s_waitcnt lgkmcnt(0)
    s_barrier
    s_setprio 2
    s_sub_u32 s12, s5, 24
    s_lshl_b32 s12, s12, 2
    s_add_u32 s14, s12, s70
    v_lshlrev_b32 v8, 7, v1
    s_lshr_b32 s13, s4, 1
    s_lshl_b32 s13, s13, 5
    s_add_u32 s12, s14, s13
    s_mul_i32 s12, s12, 20480
    s_add_u32 s48, s16, s12
    s_addc_u32 s49, s17, 0
    s_mov_b32 s50, 20480
    s_mov_b32 s51, 0x20000
    s_mov_b32 s13, 0
    buffer_load_dword v72, v8, s[48:51], s13 offen
    s_mov_b32 s13, 8192
    buffer_load_dword v73, v8, s[48:51], s13 offen
    s_mov_b32 s13, 16384
    buffer_load_dword v74, v8, s[48:51], s13 offen
    s_waitcnt vmcnt(0)
    s_mov_b32 s48, s24
    s_mov_b32 s49, s25
    s_mov_b32 s50, 2621440
    s_mov_b32 s51, 0x20000
    s_lshr_b32 s12, s9, 5
    s_lshl_b32 s12, s12, 7
    s_and_b32 s13, s9, 31
    s_mul_i32 s13, s13, 81920
    s_add_u32 s12, s12, s13
    s_add_u32 m0, s54, 0
    s_nop 0
    buffer_load_dwordx4 v9, s[48:51], s12 offen lds
    s_add_u32 s12, s12, 10240
    s_add_u32 m0, s54, 1024
    s_nop 0
    buffer_load_dwordx4 v9, s[48:51], s12 offen lds
    s_add_u32 s12, s12, 10240
    s_add_u32 m0, s54, 2048
    s_nop 0
    buffer_load_dwordx4 v9, s[48:51], s12 offen lds
    s_add_u32 s12, s12, 10240
    s_add_u32 m0, s54, 3072
    s_nop 0
    buffer_load_dwordx4 v9, s[48:51], s12 offen lds
    s_add_u32 s12, s12, 10240
    s_add_u32 m0, s54, 4096
    s_nop 0
    buffer_load_dwordx4 v9, s[48:51], s12 offen lds
    s_add_u32 s12, s12, 10240
    s_add_u32 m0, s54, 5120
    s_nop 0
    buffer_load_dwordx4 v9, s[48:51], s12 offen lds
    s_add_u32 s12, s12, 10240
    s_add_u32 m0, s54, 6144
    s_nop 0
    buffer_load_dwordx4 v9, s[48:51], s12 offen lds
    s_add_u32 s12, s12, 10240
    s_add_u32 m0, s54, 7168
    s_nop 0
    buffer_load_dwordx4 v9, s[48:51], s12 offen lds
    s_add_u32 s12, s12, 10240
    s_cmp_lg_u32 s70, 2
    s_cbranch_scc1 m_phi0b
    s_add_u32 s9, s9, 2
    s_lshr_b32 s12, s9, 5
    s_lshl_b32 s12, s12, 7
    s_and_b32 s13, s9, 31
    s_mul_i32 s13, s13, 81920
    s_add_u32 s12, s12, s13
    s_add_u32 m0, s54, 40960
    s_nop 0
    buffer_load_dwordx4 v9, s[48:51], s12 offen lds
    s_add_u32 s12, s12, 10240
    s_add_u32 m0, s54, 41984
    s_nop 0
    buffer_load_dwordx4 v9, s[48:51], s12 offen lds
    s_add_u32 s12, s12, 10240
    s_add_u32 m0, s54, 43008
    s_nop 0
    buffer_load_dwordx4 v9, s[48:51], s12 offen lds
    s_add_u32 s12, s12, 10240
    s_add_u32 m0, s54, 44032
    s_nop 0
    buffer_load_dwordx4 v9, s[48:51], s12 offen lds
    s_add_u32 s12, s12, 10240
    s_add_u32 m0, s54, 45056
    s_nop 0
    buffer_load_dwordx4 v9, s[48:51], s12 offen lds
    s_add_u32 s12, s12, 10240
    s_add_u32 m0, s54, 46080
    s_nop 0
    buffer_load_dwordx4 v9, s[48:51], s12 offen lds
    s_add_u32 s12, s12, 10240
    s_add_u32 m0, s54, 47104
    s_nop 0
    buffer_load_dwordx4 v9, s[48:51], s12 offen lds
    s_add_u32 s12, s12, 10240
    s_add_u32 m0, s54, 48128
    s_nop 0
    buffer_load_dwordx4 v9, s[48:51], s12 offen lds
    s_add_u32 s12, s12, 10240
    s_sub_u32 s9, s9, 2
m_phi0b:
    s_cmp_ge_u32 s70, 2
    s_cbranch_scc1 m_phi1z
    s_cmp_ge_u32 s6, 40
    s_cbranch_scc1 m_phi1z
    s_mul_i32 s52, s6, 6554
    s_lshr_b32 s52, s52, 16
    s_mul_i32 s53, s52, 10
    s_sub_u32 s53, s6, s53
    s_lshl_b32 s53, s53, 1
    s_add_u32 s53, s53, s70
    s_mul_i32 s12, s53, 40
    s_sub_u32 s13, s53, 16
    s_mul_i32 s13, s13, 160
    s_add_u32 s13, s13, 16
    s_cmp_lt_u32 s53, 16
    s_cselect_b32 s12, s12, s13
    s_cselect_b32 s14, 4, 2
    s_cselect_b32 s15, 4, 16
    s_mul_i32 s12, s12, 1280
    s_mul_i32 s13, s52, 320
    s_add_u32 s12, s12, s13
    s_mov_b32 s48, s22
    s_mov_b32 s49, s23
    s_mov_b32 s50, 819200
    s_mov_b32 s51, 0x20000
    v_add_u32 v8, 0, v1
    v_mul_u32_u24 v9, 3277, v8
    v_lshrrev_b32 v9, 16, v9
    v_mul_u32_u24 v10, 20, v9
    v_sub_u32 v10, v8, v10
    v_lshrrev_b32 v8, s14, v9
    v_mad_u32_u24 v9, v8, s15, v9
    v_mul_u32_u24 v9, 1280, v9
    v_lshl_add_u32 v9, v10, 4, v9
    s_add_u32 m0, s54, 40960
    s_nop 0
    buffer_load_dwordx4 v9, s[48:51], s12 offen lds
    v_add_u32 v8, 64, v1
    v_mul_u32_u24 v9, 3277, v8
    v_lshrrev_b32 v9, 16, v9
    v_mul_u32_u24 v10, 20, v9
    v_sub_u32 v10, v8, v10
    v_lshrrev_b32 v8, s14, v9
    v_mad_u32_u24 v9, v8, s15, v9
    v_mul_u32_u24 v9, 1280, v9
    v_lshl_add_u32 v9, v10, 4, v9
    s_add_u32 m0, s54, 41984
    s_nop 0
    buffer_load_dwordx4 v9, s[48:51], s12 offen lds
    v_add_u32 v8, 128, v1
    v_mul_u32_u24 v9, 3277, v8
    v_lshrrev_b32 v9, 16, v9
    v_mul_u32_u24 v10, 20, v9
    v_sub_u32 v10, v8, v10
    v_lshrrev_b32 v8, s14, v9
    v_mad_u32_u24 v9, v8, s15, v9
    v_mul_u32_u24 v9, 1280, v9
    v_lshl_add_u32 v9, v10, 4, v9
    s_add_u32 m0, s54, 43008
    s_nop 0
    buffer_load_dwordx4 v9, s[48:51], s12 offen lds
    v_add_u32 v8, 192, v1
    v_mul_u32_u24 v9, 3277, v8
    v_lshrrev_b32 v9, 16, v9
    v_mul_u32_u24 v10, 20, v9
    v_sub_u32 v10, v8, v10
    v_lshrrev_b32 v8, s14, v9
    v_mad_u32_u24 v9, v8, s15, v9
    v_mul_u32_u24 v9, 1280, v9
    v_lshl_add_u32 v9, v10, 4, v9
    s_add_u32 m0, s54, 44032
    s_nop 0
    buffer_load_dwordx4 v9, s[48:51], s12 offen lds
    v_add_u32 v8, 256, v1
    v_mul_u32_u24 v9, 3277, v8
    v_lshrrev_b32 v9, 16, v9
    v_mul_u32_u24 v10, 20, v9
    v_sub_u32 v10, v8, v10
    v_lshrrev_b32 v8, s14, v9
    v_mad_u32_u24 v9, v8, s15, v9
    v_mul_u32_u24 v9, 1280, v9
    v_lshl_add_u32 v9, v10, 4, v9
    s_add_u32 m0, s54, 45056
    s_nop 0
    buffer_load_dwordx4 v9, s[48:51], s12 offen lds
    v_add_u32 v8, 320, v1
    v_mul_u32_u24 v9, 3277, v8
    v_lshrrev_b32 v9, 16, v9
    v_mul_u32_u24 v10, 20, v9
    v_sub_u32 v10, v8, v10
    v_lshrrev_b32 v8, s14, v9
    v_mad_u32_u24 v9, v8, s15, v9
    v_mul_u32_u24 v9, 1280, v9
    v_lshl_add_u32 v9, v10, 4, v9
    s_add_u32 m0, s54, 46080
    s_nop 0
    buffer_load_dwordx4 v9, s[48:51], s12 offen lds
    v_add_u32 v8, 384, v1
    v_mul_u32_u24 v9, 3277, v8
    v_lshrrev_b32 v9, 16, v9
    v_mul_u32_u24 v10, 20, v9
    v_sub_u32 v10, v8, v10
    v_lshrrev_b32 v8, s14, v9
    v_mad_u32_u24 v9, v8, s15, v9
    v_mul_u32_u24 v9, 1280, v9
    v_lshl_add_u32 v9, v10, 4, v9
    s_add_u32 m0, s54, 47104
    s_nop 0
    buffer_load_dwordx4 v9, s[48:51], s12 offen lds
    v_add_u32 v8, 448, v1
    v_mul_u32_u24 v9, 3277, v8
    v_lshrrev_b32 v9, 16, v9
    v_mul_u32_u24 v10, 20, v9
    v_sub_u32 v10, v8, v10
    v_lshrrev_b32 v8, s14, v9
    v_mad_u32_u24 v9, v8, s15, v9
    v_mul_u32_u24 v9, 1280, v9
    v_lshl_add_u32 v9, v10, 4, v9
    s_add_u32 m0, s54, 48128
    s_nop 0
    buffer_load_dwordx4 v9, s[48:51], s12 offen lds
    v_add_u32 v8, 512, v1
    v_mul_u32_u24 v9, 3277, v8
    v_lshrrev_b32 v9, 16, v9
    v_mul_u32_u24 v10, 20, v9
    v_sub_u32 v10, v8, v10
    v_lshrrev_b32 v8, s14, v9
    v_mad_u32_u24 v9, v8, s15, v9
    v_mul_u32_u24 v9, 1280, v9
    v_lshl_add_u32 v9, v10, 4, v9
    s_add_u32 m0, s54, 49152
    s_nop 0
    buffer_load_dwordx4 v9, s[48:51], s12 offen lds
    v_add_u32 v8, 576, v1
    v_mul_u32_u24 v9, 3277, v8
    v_lshrrev_b32 v9, 16, v9
    v_mul_u32_u24 v10, 20, v9
    v_sub_u32 v10, v8, v10
    v_lshrrev_b32 v8, s14, v9
    v_mad_u32_u24 v9, v8, s15, v9
    v_mul_u32_u24 v9, 1280, v9
    v_lshl_add_u32 v9, v10, 4, v9
    s_add_u32 m0, s54, 50176
    s_nop 0
    buffer_load_dwordx4 v9, s[48:51], s12 offen lds
    s_waitcnt vmcnt(10)
    s_branch m_phi1
m_load:
    v_mov_b32 v19, 45056
    s_lshl_b32 s12, s64, 2
    s_load_dwordx2 s[40:41], s[40:41], s12
    s_add_u32 s56, s46, 21037056
    s_addc_u32 s57, s47, 0
    s_mov_b32 s58, 65536
    s_mov_b32 s59, 0x20000
    s_mov_b32 s60, s44
    s_mov_b32 s61, s45
    s_mov_b32 s62, 256
    s_mov_b32 s63, 0x20000
    s_mov_b32 s65, 9
m_ld:
    s_lshl_b32 s12, s73, 7
    s_mul_i32 s13, s73, 245760
    s_add_u32 m0, s9, 0
    s_nop 0
    buffer_load_dwordx4 v240, s[48:51], s12 offen lds
    s_add_u32 m0, s9, 1024
    s_nop 0
    buffer_load_dwordx4 v241, s[48:51], s12 offen lds
    s_add_u32 m0, s9, 2048
    s_nop 0
    buffer_load_dwordx4 v242, s[48:51], s12 offen lds
    s_add_u32 m0, s9, 3072
    s_nop 0
    buffer_load_dwordx4 v243, s[48:51], s12 offen lds
    s_add_u32 m0, s10, 0
    s_nop 0
    buffer_load_dwordx4 v244, s[52:55], s13 offen lds
    s_add_u32 m0, s10, 1024
    s_nop 0
    buffer_load_dwordx4 v245, s[52:55], s13 offen lds
    s_add_u32 m0, s10, 2048
    s_nop 0
    buffer_load_dwordx4 v246, s[52:55], s13 offen lds
    s_add_u32 m0, s10, 3072
    s_nop 0
    buffer_load_dwordx4 v247, s[52:55], s13 offen lds
    s_add_u32 m0, s10, 4096
    s_nop 0
    buffer_load_dwordx4 v248, s[52:55], s13 offen lds
    s_add_u32 s73, s73, 1
    s_cmp_eq_u32 s73, 10
    s_cselect_b32 s73, 0, s73
    s_add_u32 s9, s9, 36864
    s_add_u32 s10, s10, 36864
    s_cmp_ge_u32 s9, 110592
    s_cselect_b32 s12, 110592, 0
    s_sub_u32 s9, s9, s12
    s_sub_u32 s10, s10, s12
    s_waitcnt vmcnt(9)
    s_barrier
    s_sub_u32 s65, s65, 1
    s_cmp_lg_u32 s65, 0
    s_cbranch_scc1 m_ld
    buffer_load_dword v11, v255, s[60:63], 0 offen sc1
    s_mov_b32 s12, 0
    v_mul_u32_u24 v8, 800, v4
    v_mul_u32_u24 v9, 40, v5
    v_add3_u32 v8, v8, v9, s12
    v_mov_b32 v16, 3200
    v_cmp_eq_u32 vcc, v6, v4
    s_nop 1
    v_cndmask_b32 v16, v16, v8, vcc
    v_add_u32 v16, 147456, v16
    ds_read_b64_tr_b16 v[20:21], v16 offset:0
    ds_read_b64_tr_b16 v[22:23], v16 offset:160
    ds_read_b64_tr_b16 v[24:25], v16 offset:320
    ds_read_b64_tr_b16 v[26:27], v16 offset:480
    ds_read_b64_tr_b16 v[28:29], v16 offset:640
    ds_read_b64_tr_b16 v[30:31], v16 offset:8
    ds_read_b64_tr_b16 v[32:33], v16 offset:168
    ds_read_b64_tr_b16 v[34:35], v16 offset:328
    ds_read_b64_tr_b16 v[36:37], v16 offset:488
    ds_read_b64_tr_b16 v[38:39], v16 offset:648
    ds_read_b64_tr_b16 v[40:41], v16 offset:16
    ds_read_b64_tr_b16 v[42:43], v16 offset:176
    ds_read_b64_tr_b16 v[44:45], v16 offset:336
    ds_read_b64_tr_b16 v[46:47], v16 offset:496
    ds_read_b64_tr_b16 v[48:49], v16 offset:656
    ds_read_b64_tr_b16 v[50:51], v16 offset:24
    ds_read_b64_tr_b16 v[52:53], v16 offset:184
    ds_read_b64_tr_b16 v[54:55], v16 offset:344
    ds_read_b64_tr_b16 v[56:57], v16 offset:504
    ds_read_b64_tr_b16 v[58:59], v16 offset:664
    ds_read_b64_tr_b16 v[60:61], v16 offset:32
    ds_read_b64_tr_b16 v[62:63], v16 offset:192
    ds_read_b64_tr_b16 v[64:65], v16 offset:352
    ds_read_b64_tr_b16 v[66:67], v16 offset:512
    ds_read_b64_tr_b16 v[68:69], v16 offset:672
    s_waitcnt vmcnt(1)
    s_barrier
    s_lshl_b32 s12, s4, 2
    s_and_b32 s13, s5, 3
    s_add_u32 s12, s12, s13
    s_mul_i32 s12, s12, 800
    s_and_b32 s13, s70, 1
    s_lshl_b32 s13, s13, 10
    v_add_u32 v8, s13, v7
    s_add_u32 s48, s20, s12
    s_addc_u32 s49, s21, 0
    s_mov_b32 s50, 800
    s_mov_b32 s51, 0x20000
    s_add_u32 m0, s13, 71680
    s_nop 0
    buffer_load_dwordx4 v8, s[48:51], 0 offen lds
    s_cmp_lt_u32 s7, 4
    s_cbranch_scc1 m_l_c
    s_waitcnt vmcnt(1)
    v_cmp_ne_u32 vcc, 0, v11
    s_nop 0
    s_cmp_eq_u64 vcc, -1
    s_cbranch_scc1 m_cp3
    s_mov_b32 s71, 40000
m_poll4:
    buffer_load_dword v11, v255, s[60:63], 0 offen sc1
    s_waitcnt vmcnt(0)
    v_cmp_ne_u32 vcc, 0, v11
    s_nop 0
    s_cmp_eq_u64 vcc, -1
    s_cbranch_scc1 m_pd5
    s_sleep 4
    s_sub_u32 s71, s71, 1
    s_cmp_lg_u32 s71, 0
    s_cbranch_scc1 m_poll4
m_pd5:
m_cp3:
    s_lshr_b32 s12, s64, 5
    s_lshl_b32 s12, s12, 5
    s_lshl_b32 s13, s70, 3
    s_add_u32 s12, s12, s13
    v_and_b32 v9, 7, v1
    v_add_u32 v8, s12, v9
    v_mul_u32_u24 v8, 13108, v8
    v_lshrrev_b32 v8, 16, v8
    v_add_u32 v14, 0, v8
    v_lshlrev_b32 v14, 7, v14
    buffer_load_dword v15, v14, s[56:59], 0 offen sc1
    s_lshr_b32 s12, s70, 1
    s_mul_i32 s14, s12, 16704
    s_add_u32 s14, s14, 121280
    s_mul_i32 s15, s12, 4608
    s_add_u32 s15, s15, 154624
    v_sub_u32 v8, 15, v3
    v_and_b32 v9, 3, v8
    v_mul_u32_u24 v208, 4160, v9
    v_lshrrev_b32 v8, 2, v8
    v_lshl_add_u32 v208, v8, 3, v208
    v_lshl_add_u32 v208, v4, 4, v208
    s_and_b32 s12, s70, 1
    s_lshl_b32 s12, s12, 8
    s_sub_u32 s12, s12, s74
    s_add_u32 s13, s12, s14
    v_add_u32 v208, s13, v208
    v_lshlrev_b32 v209, 5, v3
    v_lshl_add_u32 v209, v4, 4, v209
    s_add_u32 s13, s12, s15
    v_add_u32 v209, s13, v209
    s_and_b32 s12, s4, 3
    s_lshl_b32 s12, s12, 5
    s_lshr_b32 s13, s4, 2
    s_add_u32 s12, s12, s13
    s_add_u32 s12, s12, 256
    v_lshl_add_u32 v253, v6, 3, s12
    v_lshl_add_u32 v253, v5, 1, v253
    s_lshr_b32 s13, s5, 3
    s_mul_i32 s13, s13, 10
    s_add_u32 s13, s13, 448
    v_min_u32 v8, 9, v3
    v_cmp_le_u32 vcc, 32, v1
    v_add_u32 v8, s13, v8
    v_lshlrev_b32 v11, 7, v8
    v_cndmask_b32 v253, v253, v8, vcc
    v_lshlrev_b32 v253, 7, v253
    s_cmp_lg_u32 s69, 0
    s_cselect_b64 vcc, -1, 0
    s_lshr_b32 s12, s5, 2
    s_lshl_b32 s12, s12, 1
    s_lshr_b32 s13, s70, 1
    s_add_u32 s12, s12, s13
    s_and_b32 s13, s12, 3
    s_lshl_b32 s13, s13, 3
    s_lshr_b32 s12, s12, 2
    s_lshl_b32 s12, s12, 1
    s_add_u32 s12, s12, s13
    s_lshr_b32 s13, s4, 2
    s_add_u32 s12, s12, s13
    s_bfe_u32 s13, s4, 65537
    s_lshl_b32 s13, s13, 5
    s_add_u32 s12, s12, s13
    s_add_u32 s12, s12, 64
    s_lshl_b32 s12, s12, 7
    v_mov_b32 v8, s12
    v_cndmask_b32 v14, v8, v14, vcc
    s_barrier
    s_waitcnt vmcnt(0)
    v_cmp_ne_u32 vcc, 0, v15
    s_nop 0
    s_cmp_eq_u64 vcc, -1
    s_cbranch_scc1 m_cp6
    s_mov_b32 s71, 40000
m_poll7:
    buffer_load_dword v15, v14, s[56:59], 0 offen sc1
    s_waitcnt vmcnt(0)
    v_cmp_ne_u32 vcc, 0, v15
    s_nop 0
    s_cmp_eq_u64 vcc, -1
    s_cbranch_scc1 m_pd8
    s_sleep 4
    s_sub_u32 s71, s71, 1
    s_cmp_lg_u32 s71, 0
    s_cbranch_scc1 m_poll7
m_pd8:
m_cp6:
    s_lshl_b32 s12, s64, 13
    s_lshl_b32 s13, s70, 10
    s_add_u32 s14, s13, 4096
    s_add_u32 s48, s46, 12582912
    s_addc_u32 s49, s47, 0
    s_add_u32 s48, s48, s12
    s_addc_u32 s49, s49, 0
    s_mov_b32 s50, 8192
    s_mov_b32 s51, 0x20000
    s_sub_u32 s15, s13, s74
    s_add_u32 m0, s15, 155104
    s_nop 0
    buffer_load_dwordx4 v7, s[48:51], s13 offen sc1 lds
    s_add_u32 m0, s15, 159712
    s_nop 0
    buffer_load_dwordx4 v7, s[48:51], s14 offen sc1 lds
    s_mov_b32 s71, 4
    v_mov_b32 v254, 163820
m_dw9:
    ds_read_b32 v255, v254
    s_waitcnt lgkmcnt(0)
    v_readfirstlane_b32 s11, v255
    s_nop 0
    s_cmp_ge_u32 s11, s71
    s_cbranch_scc1 m_dd10
    s_sleep 1
    s_branch m_dw9
m_dd10:
    s_mov_b32 s11, -1
    v_mov_b32 v136, -1
    v_mov_b32 v137, -1
    v_mov_b32 v138, -1
    v_mov_b32 v139, -1
    s_lshl_b32 s12, s4, 2
    s_and_b32 s13, s5, 3
    s_add_u32 s12, s12, s13
    s_lshr_b32 s13, s5, 2
    s_lshl_b32 s13, s13, 4
    s_lshl_b32 s14, s70, 2
    s_add_u32 s13, s13, s14
    s_mul_i32 s13, s13, 20480
    v_lshrrev_b32 v8, 5, v1
    v_mul_u32_u24 v8, 19968, v8
    v_add_u32 v8, v8, v7
    v_bfe_u32 v9, v1, 3, 2
    v_mul_u32_u24 v9, 20480, v9
    v_and_b32 v10, 7, v1
    v_lshl_add_u32 v9, v10, 4, v9
    s_lshl_b32 s14, s12, 9
    s_add_u32 s15, s14, 40960
    s_lshl_b32 s12, s12, 7
    s_add_u32 s12, s12, 16384
    s_add_u32 s48, s46, 7012352
    s_addc_u32 s49, s47, 0
    s_add_u32 s48, s48, s13
    s_addc_u32 s49, s49, 0
    s_mov_b32 s50, 81920
    s_mov_b32 s51, 0x20000
    buffer_store_dwordx4 v[136:139], v8, s[48:51], s14 offen sc1
    buffer_store_dwordx4 v[136:139], v8, s[48:51], s15 offen sc1
    buffer_store_dwordx4 v[136:139], v9, s[48:51], s12 offen sc1
    s_lshl_b32 s12, s64, 13
    s_lshl_b32 s13, s70, 11
    s_add_u32 s48, s46, 9633792
    s_addc_u32 s49, s47, 0
    s_add_u32 s48, s48, s12
    s_addc_u32 s49, s49, 0
    s_mov_b32 s50, 16384
    s_mov_b32 s51, 0x20000
    buffer_store_dwordx4 v[136:139], v7, s[48:51], s13 offen offset:0 sc1
    buffer_store_dwordx4 v[136:139], v7, s[48:51], s13 offen offset:1024 sc1
    s_add_u32 s12, s8, s70
    s_lshl_b32 s12, s12, 4
    s_add_u32 s12, s12, s6
    s_mul_i32 s12, s12, 3456
    s_cmp_lt_u32 s7, 4
    s_cselect_b32 s13, 3360, 0
    s_cselect_b32 s12, s12, 0
    s_add_u32 s48, s46, 5242880
    s_addc_u32 s49, s47, 0
    s_add_u32 s48, s48, s12
    s_addc_u32 s49, s49, 0
    s_mov_b32 s50, s13
    s_mov_b32 s51, 0x20000
    buffer_store_dwordx4 v[136:139], v7, s[48:51], 0 offen offset:0 sc1
    buffer_store_dwordx4 v[136:139], v7, s[48:51], 0 offen offset:1024 sc1
    buffer_store_dwordx4 v[136:139], v7, s[48:51], 0 offen offset:2048 sc1
    buffer_store_dwordx4 v[136:139], v7, s[48:51], 0 offen offset:3072 sc1
    buffer_load_dword v254, v253, s[56:59], 0 offen sc1
    s_add_u32 s72, s2, 256
    s_cmp_eq_u32 s72, -1
    s_cbranch_scc1 m_cs11
    v_mov_b32 v8, 163816
    s_waitcnt vmcnt(0)
    s_mov_b64 exec, 1
    ds_add_rtn_u32 v9, v8, v12
    s_mov_b64 exec, -1
    s_waitcnt lgkmcnt(0)
    v_readfirstlane_b32 s12, v9
    s_nop 0
    s_and_b32 s12, s12, 3
    s_cmp_lg_u32 s12, 3
    s_cbranch_scc1 m_cs11
    s_mov_b32 s11, s72
    s_lshl_b32 s11, s11, 7
    s_mov_b64 exec, 1
    buffer_store_dword v12, v13, s[56:59], s11 offen sc1
    s_mov_b64 exec, -1
    s_mov_b32 s11, -1
m_cs11:
    s_mov_b32 s72, -1
    s_branch m_conv
m_l_c:
    v_mov_b32 v136, -1
    v_mov_b32 v137, -1
    v_mov_b32 v138, -1
    v_mov_b32 v139, -1
    s_lshl_b32 s12, s4, 2
    s_and_b32 s13, s5, 3
    s_add_u32 s12, s12, s13
    s_lshr_b32 s13, s5, 2
    s_lshl_b32 s13, s13, 4
    s_lshl_b32 s14, s70, 2
    s_add_u32 s13, s13, s14
    s_mul_i32 s13, s13, 20480
    v_lshrrev_b32 v8, 5, v1
    v_mul_u32_u24 v8, 19968, v8
    v_add_u32 v8, v8, v7
    v_bfe_u32 v9, v1, 3, 2
    v_mul_u32_u24 v9, 20480, v9
    v_and_b32 v10, 7, v1
    v_lshl_add_u32 v9, v10, 4, v9
    s_lshl_b32 s14, s12, 9
    s_add_u32 s15, s14, 40960
    s_lshl_b32 s12, s12, 7
    s_add_u32 s12, s12, 16384
    s_add_u32 s48, s46, 7012352
    s_addc_u32 s49, s47, 0
    s_add_u32 s48, s48, s13
    s_addc_u32 s49, s49, 0
    s_mov_b32 s50, 81920
    s_mov_b32 s51, 0x20000
    buffer_store_dwordx4 v[136:139], v8, s[48:51], s14 offen sc1
    buffer_store_dwordx4 v[136:139], v8, s[48:51], s15 offen sc1
    buffer_store_dwordx4 v[136:139], v9, s[48:51], s12 offen sc1
    s_lshl_b32 s12, s64, 13
    s_lshl_b32 s13, s70, 11
    s_add_u32 s48, s46, 9633792
    s_addc_u32 s49, s47, 0
    s_add_u32 s48, s48, s12
    s_addc_u32 s49, s49, 0
    s_mov_b32 s50, 16384
    s_mov_b32 s51, 0x20000
    buffer_store_dwordx4 v[136:139], v7, s[48:51], s13 offen offset:0 sc1
    buffer_store_dwordx4 v[136:139], v7, s[48:51], s13 offen offset:1024 sc1
    s_add_u32 s12, s8, s70
    s_lshl_b32 s12, s12, 4
    s_add_u32 s12, s12, s6
    s_mul_i32 s12, s12, 3456
    s_cmp_lt_u32 s7, 4
    s_cselect_b32 s13, 3360, 0
    s_cselect_b32 s12, s12, 0
    s_add_u32 s48, s46, 5242880
    s_addc_u32 s49, s47, 0
    s_add_u32 s48, s48, s12
    s_addc_u32 s49, s49, 0
    s_mov_b32 s50, s13
    s_mov_b32 s51, 0x20000
    buffer_store_dwordx4 v[136:139], v7, s[48:51], 0 offen offset:0 sc1
    buffer_store_dwordx4 v[136:139], v7, s[48:51], 0 offen offset:1024 sc1
    buffer_store_dwordx4 v[136:139], v7, s[48:51], 0 offen offset:2048 sc1
    buffer_store_dwordx4 v[136:139], v7, s[48:51], 0 offen offset:3072 sc1
    s_waitcnt vmcnt(10)
    v_cmp_ne_u32 vcc, 0, v11
    s_nop 0
    s_cmp_eq_u64 vcc, -1
    s_cbranch_scc1 m_cp12
    s_mov_b32 s71, 40000
m_poll13:
    buffer_load_dword v11, v255, s[60:63], 0 offen sc1
    s_waitcnt vmcnt(0)
    v_cmp_ne_u32 vcc, 0, v11
    s_nop 0
    s_cmp_eq_u64 vcc, -1
    s_cbranch_scc1 m_pd14
    s_sleep 4
    s_sub_u32 s71, s71, 1
    s_cmp_lg_u32 s71, 0
    s_cbranch_scc1 m_poll13
m_pd14:
m_cp12:
    s_lshr_b32 s12, s64, 5
    s_lshl_b32 s12, s12, 5
    s_lshl_b32 s13, s70, 3
    s_add_u32 s12, s12, s13
    v_and_b32 v9, 7, v1
    v_add_u32 v8, s12, v9
    v_mul_u32_u24 v8, 13108, v8
    v_lshrrev_b32 v8, 16, v8
    v_add_u32 v14, 0, v8
    v_lshlrev_b32 v14, 7, v14
    buffer_load_dword v15, v14, s[56:59], 0 offen sc1
    s_lshl_b32 s12, s5, 2
    s_add_u32 s12, s12, s70
    s_mul_i32 s12, s12, 12800
    v_lshlrev_b32 v8, 7, v1
    v_add_u32 v9, 8192, v8
    s_add_u32 s48, s46, 20185088
    s_addc_u32 s49, s47, 0
    s_add_u32 s48, s48, s12
    s_addc_u32 s49, s49, 0
    s_mov_b32 s50, 12800
    s_mov_b32 s51, 0x20000
    buffer_load_dword v142, v8, s[48:51], 0 offen sc1
    buffer_load_dword v143, v9, s[48:51], 0 offen sc1
    s_lshr_b32 s12, s70, 1
    s_mul_i32 s14, s12, 16704
    s_add_u32 s14, s14, 121280
    s_mul_i32 s15, s12, 4608
    s_add_u32 s15, s15, 154624
    v_sub_u32 v8, 15, v3
    v_and_b32 v9, 3, v8
    v_mul_u32_u24 v208, 4160, v9
    v_lshrrev_b32 v8, 2, v8
    v_lshl_add_u32 v208, v8, 3, v208
    v_lshl_add_u32 v208, v4, 4, v208
    s_and_b32 s12, s70, 1
    s_lshl_b32 s12, s12, 8
    s_sub_u32 s12, s12, s74
    s_add_u32 s13, s12, s14
    v_add_u32 v208, s13, v208
    v_lshlrev_b32 v209, 5, v3
    v_lshl_add_u32 v209, v4, 4, v209
    s_add_u32 s13, s12, s15
    v_add_u32 v209, s13, v209
    s_and_b32 s12, s4, 3
    s_lshl_b32 s12, s12, 5
    s_lshr_b32 s13, s4, 2
    s_add_u32 s12, s12, s13
    s_add_u32 s12, s12, 256
    v_lshl_add_u32 v253, v6, 3, s12
    v_lshl_add_u32 v253, v5, 1, v253
    s_lshr_b32 s13, s5, 3
    s_mul_i32 s13, s13, 10
    s_add_u32 s13, s13, 448
    v_min_u32 v8, 9, v3
    v_cmp_le_u32 vcc, 32, v1
    v_add_u32 v8, s13, v8
    v_lshlrev_b32 v11, 7, v8
    v_cndmask_b32 v253, v253, v8, vcc
    v_lshlrev_b32 v253, 7, v253
    s_cmp_lg_u32 s69, 0
    s_cselect_b64 vcc, -1, 0
    s_lshr_b32 s12, s5, 2
    s_lshl_b32 s12, s12, 1
    s_lshr_b32 s13, s70, 1
    s_add_u32 s12, s12, s13
    s_and_b32 s13, s12, 3
    s_lshl_b32 s13, s13, 3
    s_lshr_b32 s12, s12, 2
    s_lshl_b32 s12, s12, 1
    s_add_u32 s12, s12, s13
    s_lshr_b32 s13, s4, 2
    s_add_u32 s12, s12, s13
    s_bfe_u32 s13, s4, 65537
    s_lshl_b32 s13, s13, 5
    s_add_u32 s12, s12, s13
    s_add_u32 s12, s12, 64
    s_lshl_b32 s12, s12, 7
    v_mov_b32 v8, s12
    v_cndmask_b32 v14, v8, v14, vcc
    v_lshl_add_u32 v8, v4, 2, v5
    v_mul_u32_u24 v250, 352, v8
    s_mul_i32 s12, s70, 80
    s_add_u32 s12, s12, 0
    v_add_u32 v250, s12, v250
    v_lshl_add_u32 v250, v6, 3, v250
    v_mul_u32_u24 v251, 176, v8
    v_add_u32 v251, 88064, v251
    s_mul_i32 s12, s70, 40
    v_lshl_add_u32 v8, v6, 3, s12
    s_add_u32 s12, s12, 32
    v_mov_b32 v9, s12
    v_mov_b32 v10, 160
    v_cmp_eq_u32 vcc, 0, v6
    s_lshl_b32 s13, s69, 4
    s_sub_u32 s14, 16, s13
    v_cndmask_b32 v9, v10, v9, vcc
    s_cmp_lg_u32 s69, 0
    s_cselect_b64 vcc, -1, 0
    v_cndmask_b32 v8, v8, v9, vcc
    v_add_u32 v251, v251, v8
    s_max_u32 s14, s14, 5
    v_mul_u32_u24 v8, 21, v4
    v_cmp_gt_u32 vcc, s14, v3
    v_add3_u32 v8, v8, v3, s13
    v_lshlrev_b32 v8, 4, v8
    v_mov_b32 v9, 0x10000
    v_cndmask_b32 v252, v9, v8, vcc
m_l_kv:
    s_and_b32 s9, s70, 1
    s_lshl_b32 s9, s9, 2
    s_lshr_b32 s13, s70, 1
    s_add_u32 s9, s9, s13
    s_add_u32 s12, s9, 1
    s_mul_i32 s12, s12, 3072
    v_add3_u32 v10, s12, v7, v19
    s_add_u32 s9, s9, 2
    s_waitcnt lgkmcnt(0)
    s_barrier
    ds_read_b128 v[72:75], v10 offset:0
    ds_read_b128 v[76:79], v10 offset:1024
    ds_read_b64 v[80:81], v10 offset:2048
m_unit0:
    s_lshl_b32 s13, s9, 4
    v_add_u32 v8, s13, v3
    v_mul_u32_u24 v17, 352, v8
    v_mul_u32_u24 v8, 80, v4
    v_add_u32 v17, v17, v8
    v_add_u32 v17, 0, v17
    s_waitcnt lgkmcnt(2)
    v_mfma_f32_16x16x32_bf16 v[144:147], v[20:23], v[72:75], 0
    v_mfma_f32_16x16x32_bf16 v[148:151], v[30:33], v[72:75], 0
    v_mfma_f32_16x16x32_bf16 v[152:155], v[40:43], v[72:75], 0
    v_mfma_f32_16x16x32_bf16 v[156:159], v[50:53], v[72:75], 0
    v_mfma_f32_16x16x32_bf16 v[160:163], v[60:63], v[72:75], 0
    s_waitcnt lgkmcnt(1)
    v_mfma_f32_16x16x32_bf16 v[144:147], v[24:27], v[76:79], v[144:147]
    v_mfma_f32_16x16x32_bf16 v[148:151], v[34:37], v[76:79], v[148:151]
    v_mfma_f32_16x16x32_bf16 v[152:155], v[44:47], v[76:79], v[152:155]
    v_mfma_f32_16x16x32_bf16 v[156:159], v[54:57], v[76:79], v[156:159]
    v_mfma_f32_16x16x32_bf16 v[160:163], v[64:67], v[76:79], v[160:163]
    s_waitcnt lgkmcnt(0)
    v_mfma_f32_16x16x16_bf16 v[144:147], v[28:29], v[80:81], v[144:147]
    v_mfma_f32_16x16x16_bf16 v[148:151], v[38:39], v[80:81], v[148:151]
    v_mfma_f32_16x16x16_bf16 v[152:155], v[48:49], v[80:81], v[152:155]
    v_mfma_f32_16x16x16_bf16 v[156:159], v[58:59], v[80:81], v[156:159]
    v_mfma_f32_16x16x16_bf16 v[160:163], v[68:69], v[80:81], v[160:163]
    s_nop 3
    v_max3_f32 v204, v144, v145, v146
    v_min3_f32 v206, v144, v145, v146
    v_max3_f32 v204, v204, v147, v148
    v_min3_f32 v206, v206, v147, v148
    v_max3_f32 v204, v204, v149, v150
    v_min3_f32 v206, v206, v149, v150
    v_max3_f32 v204, v204, v151, v152
    v_min3_f32 v206, v206, v151, v152
    v_max3_f32 v204, v204, v153, v154
    v_min3_f32 v206, v206, v153, v154
    v_max3_f32 v204, v204, v155, v156
    v_min3_f32 v206, v206, v155, v156
    v_max3_f32 v204, v204, v157, v158
    v_min3_f32 v206, v206, v157, v158
    v_max3_f32 v204, v204, v159, v160
    v_min3_f32 v206, v206, v159, v160
    v_max3_f32 v204, v204, v161, v162
    v_min3_f32 v206, v206, v161, v162
    v_max_f32 v204, v204, v163
    v_min_f32 v206, v206, v163
    v_mul_f32_e64 v204, -v204, s66
    v_mul_f32 v206, s66, v206
    v_pk_fma_f32 v[164:165], v[144:145], s[66:67], v[204:205] op_sel:[0,0,0] op_sel_hi:[1,0,0]
    v_pk_fma_f32 v[184:185], v[144:145], s[66:67], v[206:207] op_sel:[0,0,0] op_sel_hi:[1,0,0] neg_lo:[1,0,0] neg_hi:[1,0,0]
    v_pk_fma_f32 v[166:167], v[146:147], s[66:67], v[204:205] op_sel:[0,0,0] op_sel_hi:[1,0,0]
    v_pk_fma_f32 v[186:187], v[146:147], s[66:67], v[206:207] op_sel:[0,0,0] op_sel_hi:[1,0,0] neg_lo:[1,0,0] neg_hi:[1,0,0]
    v_pk_fma_f32 v[168:169], v[148:149], s[66:67], v[204:205] op_sel:[0,0,0] op_sel_hi:[1,0,0]
    v_pk_fma_f32 v[188:189], v[148:149], s[66:67], v[206:207] op_sel:[0,0,0] op_sel_hi:[1,0,0] neg_lo:[1,0,0] neg_hi:[1,0,0]
    v_pk_fma_f32 v[170:171], v[150:151], s[66:67], v[204:205] op_sel:[0,0,0] op_sel_hi:[1,0,0]
    v_pk_fma_f32 v[190:191], v[150:151], s[66:67], v[206:207] op_sel:[0,0,0] op_sel_hi:[1,0,0] neg_lo:[1,0,0] neg_hi:[1,0,0]
    v_pk_fma_f32 v[172:173], v[152:153], s[66:67], v[204:205] op_sel:[0,0,0] op_sel_hi:[1,0,0]
    v_pk_fma_f32 v[192:193], v[152:153], s[66:67], v[206:207] op_sel:[0,0,0] op_sel_hi:[1,0,0] neg_lo:[1,0,0] neg_hi:[1,0,0]
    v_pk_fma_f32 v[174:175], v[154:155], s[66:67], v[204:205] op_sel:[0,0,0] op_sel_hi:[1,0,0]
    v_pk_fma_f32 v[194:195], v[154:155], s[66:67], v[206:207] op_sel:[0,0,0] op_sel_hi:[1,0,0] neg_lo:[1,0,0] neg_hi:[1,0,0]
    v_pk_fma_f32 v[176:177], v[156:157], s[66:67], v[204:205] op_sel:[0,0,0] op_sel_hi:[1,0,0]
    v_pk_fma_f32 v[196:197], v[156:157], s[66:67], v[206:207] op_sel:[0,0,0] op_sel_hi:[1,0,0] neg_lo:[1,0,0] neg_hi:[1,0,0]
    v_pk_fma_f32 v[178:179], v[158:159], s[66:67], v[204:205] op_sel:[0,0,0] op_sel_hi:[1,0,0]
    v_pk_fma_f32 v[198:199], v[158:159], s[66:67], v[206:207] op_sel:[0,0,0] op_sel_hi:[1,0,0] neg_lo:[1,0,0] neg_hi:[1,0,0]
    v_pk_fma_f32 v[180:181], v[160:161], s[66:67], v[204:205] op_sel:[0,0,0] op_sel_hi:[1,0,0]
    v_pk_fma_f32 v[200:201], v[160:161], s[66:67], v[206:207] op_sel:[0,0,0] op_sel_hi:[1,0,0] neg_lo:[1,0,0] neg_hi:[1,0,0]
    v_pk_fma_f32 v[182:183], v[162:163], s[66:67], v[204:205] op_sel:[0,0,0] op_sel_hi:[1,0,0]
    v_pk_fma_f32 v[202:203], v[162:163], s[66:67], v[206:207] op_sel:[0,0,0] op_sel_hi:[1,0,0] neg_lo:[1,0,0] neg_hi:[1,0,0]
    v_exp_f32 v164, v164
    v_exp_f32 v165, v165
    v_exp_f32 v166, v166
    v_exp_f32 v167, v167
    v_exp_f32 v168, v168
    v_exp_f32 v169, v169
    v_exp_f32 v170, v170
    v_exp_f32 v171, v171
    v_exp_f32 v172, v172
    v_exp_f32 v173, v173
    v_exp_f32 v174, v174
    v_exp_f32 v175, v175
    v_exp_f32 v176, v176
    v_exp_f32 v177, v177
    v_exp_f32 v178, v178
    v_exp_f32 v179, v179
    v_exp_f32 v180, v180
    v_exp_f32 v181, v181
    v_exp_f32 v182, v182
    v_exp_f32 v183, v183
    v_exp_f32 v184, v184
    v_exp_f32 v185, v185
    v_exp_f32 v186, v186
    v_exp_f32 v187, v187
    v_exp_f32 v188, v188
    v_exp_f32 v189, v189
    v_exp_f32 v190, v190
    v_exp_f32 v191, v191
    v_exp_f32 v192, v192
    v_exp_f32 v193, v193
    v_exp_f32 v194, v194
    v_exp_f32 v195, v195
    v_exp_f32 v196, v196
    v_exp_f32 v197, v197
    v_exp_f32 v198, v198
    v_exp_f32 v199, v199
    v_exp_f32 v200, v200
    v_exp_f32 v201, v201
    v_exp_f32 v202, v202
    v_exp_f32 v203, v203
    v_pk_add_f32 v[144:145], v[164:165], v[166:167]
    v_pk_add_f32 v[146:147], v[168:169], v[170:171]
    v_pk_add_f32 v[148:149], v[184:185], v[186:187]
    v_pk_add_f32 v[150:151], v[188:189], v[190:191]
    v_pk_add_f32 v[144:145], v[144:145], v[172:173]
    v_pk_add_f32 v[146:147], v[146:147], v[174:175]
    v_pk_add_f32 v[148:149], v[148:149], v[192:193]
    v_pk_add_f32 v[150:151], v[150:151], v[194:195]
    v_pk_add_f32 v[144:145], v[144:145], v[176:177]
    v_pk_add_f32 v[146:147], v[146:147], v[178:179]
    v_pk_add_f32 v[148:149], v[148:149], v[196:197]
    v_pk_add_f32 v[150:151], v[150:151], v[198:199]
    v_pk_add_f32 v[144:145], v[144:145], v[180:181]
    v_pk_add_f32 v[146:147], v[146:147], v[182:183]
    v_pk_add_f32 v[148:149], v[148:149], v[200:201]
    v_pk_add_f32 v[150:151], v[150:151], v[202:203]
    v_pk_add_f32 v[144:145], v[144:145], v[146:147]
    v_pk_add_f32 v[148:149], v[148:149], v[150:151]
    v_add_f32 v204, v144, v145
    v_add_f32 v206, v148, v149
    v_rcp_f32 v204, v204
    v_rcp_f32 v206, v206
    v_pk_mul_f32 v[164:165], v[164:165], v[204:205] op_sel:[0,0] op_sel_hi:[1,0]
    v_pk_mul_f32 v[166:167], v[166:167], v[204:205] op_sel:[0,0] op_sel_hi:[1,0]
    v_pk_mul_f32 v[168:169], v[168:169], v[204:205] op_sel:[0,0] op_sel_hi:[1,0]
    v_pk_mul_f32 v[170:171], v[170:171], v[204:205] op_sel:[0,0] op_sel_hi:[1,0]
    v_pk_mul_f32 v[172:173], v[172:173], v[204:205] op_sel:[0,0] op_sel_hi:[1,0]
    v_pk_mul_f32 v[174:175], v[174:175], v[204:205] op_sel:[0,0] op_sel_hi:[1,0]
    v_pk_mul_f32 v[176:177], v[176:177], v[204:205] op_sel:[0,0] op_sel_hi:[1,0]
    v_pk_mul_f32 v[178:179], v[178:179], v[204:205] op_sel:[0,0] op_sel_hi:[1,0]
    v_pk_mul_f32 v[180:181], v[180:181], v[204:205] op_sel:[0,0] op_sel_hi:[1,0]
    v_pk_mul_f32 v[182:183], v[182:183], v[204:205] op_sel:[0,0] op_sel_hi:[1,0]
    v_pk_mul_f32 v[184:185], v[184:185], v[206:207] op_sel:[0,0] op_sel_hi:[1,0]
    v_pk_mul_f32 v[186:187], v[186:187], v[206:207] op_sel:[0,0] op_sel_hi:[1,0]
    v_pk_mul_f32 v[188:189], v[188:189], v[206:207] op_sel:[0,0] op_sel_hi:[1,0]
    v_pk_mul_f32 v[190:191], v[190:191], v[206:207] op_sel:[0,0] op_sel_hi:[1,0]
    v_pk_mul_f32 v[192:193], v[192:193], v[206:207] op_sel:[0,0] op_sel_hi:[1,0]
    v_pk_mul_f32 v[194:195], v[194:195], v[206:207] op_sel:[0,0] op_sel_hi:[1,0]
    v_pk_mul_f32 v[196:197], v[196:197], v[206:207] op_sel:[0,0] op_sel_hi:[1,0]
    v_pk_mul_f32 v[198:199], v[198:199], v[206:207] op_sel:[0,0] op_sel_hi:[1,0]
    v_pk_mul_f32 v[200:201], v[200:201], v[206:207] op_sel:[0,0] op_sel_hi:[1,0]
    v_pk_mul_f32 v[202:203], v[202:203], v[206:207] op_sel:[0,0] op_sel_hi:[1,0]
    v_cvt_pk_bf16_f32 v96, v164, v165
    v_cvt_pk_bf16_f32 v97, v166, v167
    v_cvt_pk_bf16_f32 v98, v168, v169
    v_cvt_pk_bf16_f32 v99, v170, v171
    ds_write_b128 v17, v[96:99] offset:0
    v_cvt_pk_bf16_f32 v100, v172, v173
    v_cvt_pk_bf16_f32 v101, v174, v175
    v_cvt_pk_bf16_f32 v102, v176, v177
    v_cvt_pk_bf16_f32 v103, v178, v179
    ds_write_b128 v17, v[100:103] offset:16
    v_cvt_pk_bf16_f32 v104, v180, v181
    v_cvt_pk_bf16_f32 v105, v182, v183
    v_cvt_pk_bf16_f32 v106, v184, v185
    v_cvt_pk_bf16_f32 v107, v186, v187
    ds_write_b128 v17, v[104:107] offset:32
    v_cvt_pk_bf16_f32 v108, v188, v189
    v_cvt_pk_bf16_f32 v109, v190, v191
    v_cvt_pk_bf16_f32 v110, v192, v193
    v_cvt_pk_bf16_f32 v111, v194, v195
    ds_write_b128 v17, v[108:111] offset:48
    v_cvt_pk_bf16_f32 v112, v196, v197
    v_cvt_pk_bf16_f32 v113, v198, v199
    v_cvt_pk_bf16_f32 v114, v200, v201
    v_cvt_pk_bf16_f32 v115, v202, v203
    ds_write_b128 v17, v[112:115] offset:64
    s_cmp_lg_u32 s69, 0
    s_cbranch_scc1 m_u_hi
    s_waitcnt vmcnt(2)
    buffer_load_dword v15, v14, s[56:59], 0 offen sc1
    s_branch m_kcopy
m_u_hi:
    buffer_load_dword v254, v253, s[56:59], 0 offen sc1
    s_waitcnt vmcnt(3)
    v_cmp_ne_u32 vcc, 0, v15
    s_nop 0
    s_cmp_eq_u64 vcc, -1
    s_cbranch_scc1 m_cp15
    s_mov_b32 s71, 40000
m_poll16:
    buffer_load_dword v15, v14, s[56:59], 0 offen sc1
    s_waitcnt vmcnt(0)
    v_cmp_ne_u32 vcc, 0, v15
    s_nop 0
    s_cmp_eq_u64 vcc, -1
    s_cbranch_scc1 m_pd17
    s_sleep 4
    s_sub_u32 s71, s71, 1
    s_cmp_lg_u32 s71, 0
    s_cbranch_scc1 m_poll16
m_pd17:
m_cp15:
    s_lshl_b32 s12, s64, 13
    s_lshl_b32 s13, s70, 10
    s_add_u32 s14, s13, 4096
    s_add_u32 s48, s46, 12582912
    s_addc_u32 s49, s47, 0
    s_add_u32 s48, s48, s12
    s_addc_u32 s49, s49, 0
    s_mov_b32 s50, 8192
    s_mov_b32 s51, 0x20000
    s_sub_u32 s15, s13, s74
    s_add_u32 m0, s15, 155104
    s_nop 0
    buffer_load_dwordx4 v7, s[48:51], s13 offen sc1 lds
    s_add_u32 m0, s15, 159712
    s_nop 0
    buffer_load_dwordx4 v7, s[48:51], s14 offen sc1 lds
    s_add_u32 s11, s2, 256
    s_branch m_kv1
m_kcopy0:
    s_lshr_b32 s12, s70, 1
    s_mul_i32 s14, s12, 16704
    s_sub_u32 s14, s14, s74
    s_and_b32 s13, s70, 1
    s_lshl_b32 s13, s13, 11
    s_sub_u32 s13, s14, s13
    s_add_u32 s13, s13, 123800
    v_lshlrev_b32 v8, 5, v3
    v_lshlrev_b32 v9, 3, v4
    v_sub_u32 v10, v9, v8
    v_add_u32 v10, s13, v10
    v_and_b32 v8, 1, v5
    v_mul_u32_u24 v8, 8316, v8
    v_add_u32 v112, v10, v8
    v_sub_u32 v113, v10, v8
    v_add_u32 v113, 8316, v113
    s_add_u32 s14, s14, 125368
    s_mul_i32 s15, s12, 4608
    s_add_u32 s15, s15, 154624
    s_sub_u32 s15, s15, s74
    v_mul_u32_u24 v10, 4160, v4
    v_and_b32 v9, 7, v3
    v_lshl_add_u32 v10, v9, 3, v10
    v_add_u32 v10, s14, v10
    v_min_u32 v9, 59, v1
    v_lshl_add_u32 v9, v9, 3, s15
    s_bitcmp0_b32 s70, 0
    s_cselect_b64 vcc, -1, 0
    v_cndmask_b32 v10, v9, v10, vcc
    v_cvt_pk_bf16_f32 v116, v232, v233
    v_cvt_pk_bf16_f32 v117, v234, v235
    v_cvt_pk_bf16_f32 v118, v233, v234
    v_cvt_pk_bf16_f32 v119, v236, v237
    v_cvt_pk_bf16_f32 v120, v238, v239
    v_cvt_pk_bf16_f32 v121, v237, v238
    v_cvt_pk_bf16_f32 v122, v240, v241
    v_cvt_pk_bf16_f32 v123, v242, v243
    v_cvt_pk_bf16_f32 v124, v241, v242
    v_cvt_pk_bf16_f32 v125, v244, v245
    v_cvt_pk_bf16_f32 v126, v246, v247
    v_cvt_pk_bf16_f32 v127, v245, v246
    v_mov_b32 v232, v116
    v_mov_b32 v233, v117
    v_mov_b32 v234, v118
    v_mov_b32 v235, v119
    v_mov_b32 v236, v120
    v_mov_b32 v237, v121
    v_mov_b32 v238, v122
    v_mov_b32 v239, v123
    v_mov_b32 v240, v124
    v_mov_b32 v241, v125
    v_mov_b32 v242, v126
    v_mov_b32 v243, v127
    v_mov_b32 v244, v112
    v_mov_b32 v245, v113
    v_mov_b32 v246, v10
m_kcopy:
    ds_write2_b32 v246, v13, v13 offset0:0 offset1:1
    ds_write_b32 v244, v232 offset:1544
    ds_write_b32 v244, v233 offset:1548
    ds_write_b16 v244, v232 offset:5702
    ds_write_b32 v244, v234 offset:5704
    ds_write_b16_d16_hi v244, v233 offset:5708
    ds_write_b32 v245, v232 offset:1544
    ds_write_b32 v245, v233 offset:1548
    ds_write_b16 v245, v232 offset:5702
    ds_write_b32 v245, v234 offset:5704
    ds_write_b16_d16_hi v245, v233 offset:5708
    ds_write_b32 v244, v235 offset:1032
    ds_write_b32 v244, v236 offset:1036
    ds_write_b16 v244, v235 offset:5190
    ds_write_b32 v244, v237 offset:5192
    ds_write_b16_d16_hi v244, v236 offset:5196
    ds_write_b32 v245, v235 offset:1032
    ds_write_b32 v245, v236 offset:1036
    ds_write_b16 v245, v235 offset:5190
    ds_write_b32 v245, v237 offset:5192
    ds_write_b16_d16_hi v245, v236 offset:5196
    ds_write_b32 v244, v238 offset:520
    ds_write_b32 v244, v239 offset:524
    ds_write_b16 v244, v238 offset:4678
    ds_write_b32 v244, v240 offset:4680
    ds_write_b16_d16_hi v244, v239 offset:4684
    ds_write_b32 v245, v238 offset:520
    ds_write_b32 v245, v239 offset:524
    ds_write_b16 v245, v238 offset:4678
    ds_write_b32 v245, v240 offset:4680
    ds_write_b16_d16_hi v245, v239 offset:4684
    ds_write_b32 v244, v241 offset:8
    ds_write_b32 v244, v242 offset:12
    ds_write_b16 v244, v241 offset:4166
    ds_write_b32 v244, v243 offset:4168
    ds_write_b16_d16_hi v244, v242 offset:4172
    ds_write_b32 v245, v241 offset:8
    ds_write_b32 v245, v242 offset:12
    ds_write_b16 v245, v241 offset:4166
    ds_write_b32 v245, v243 offset:4168
    ds_write_b16_d16_hi v245, v242 offset:4172
    s_cmp_lt_u32 s7, 4
    s_cbranch_scc1 m_kv1
m_kcopy2:
    s_cmp_lt_u32 s7, 6
    s_cbranch_scc1 m_kc1
    s_cmp_lg_u32 s74, 0
    s_cbranch_scc1 m_prep3
    s_mov_b32 s74, 43392
    s_sub_u32 s64, s64, 1
    v_mov_b32 v232, v208
    v_mov_b32 v233, v209
    v_mov_b32 v234, v210
    v_mov_b32 v235, v211
    v_mov_b32 v236, v212
    v_mov_b32 v237, v213
    v_mov_b32 v238, v214
    v_mov_b32 v239, v215
    s_waitcnt vmcnt(5)
    v_mov_b32 v240, v216
    v_mov_b32 v241, v217
    v_mov_b32 v242, v218
    v_mov_b32 v243, v219
    s_waitcnt vmcnt(4)
    v_mov_b32 v244, v220
    v_mov_b32 v245, v221
    v_mov_b32 v246, v222
    v_mov_b32 v247, v223
    s_branch m_kcopy0
m_kc1:
    s_cmp_ge_u32 s7, 4
    s_cbranch_scc1 m_kc6
    v_mul_u32_u24 v8, 40, v5
    v_mov_b32 v197, 1024
    v_cmp_eq_u32 vcc, v6, v4
    s_nop 1
    v_cndmask_b32 v197, v197, v8, vcc
    v_add_u32 v197, 71680, v197
    ds_read_b64_tr_b16 v[200:201], v197 offset:0
    ds_read_b64_tr_b16 v[202:203], v197 offset:160
    ds_read_b64_tr_b16 v[204:205], v197 offset:320
    ds_read_b64_tr_b16 v[206:207], v197 offset:480
    ds_read_b64_tr_b16 v[208:209], v197 offset:640
    ds_read_b64_tr_b16 v[210:211], v197 offset:8
    ds_read_b64_tr_b16 v[212:213], v197 offset:168
    ds_read_b64_tr_b16 v[214:215], v197 offset:328
    ds_read_b64_tr_b16 v[216:217], v197 offset:488
    ds_read_b64_tr_b16 v[218:219], v197 offset:648
    ds_read_b64_tr_b16 v[220:221], v197 offset:16
    ds_read_b64_tr_b16 v[222:223], v197 offset:176
    ds_read_b64_tr_b16 v[224:225], v197 offset:336
    ds_read_b64_tr_b16 v[226:227], v197 offset:496
    ds_read_b64_tr_b16 v[228:229], v197 offset:656
    ds_read_b64_tr_b16 v[230:231], v197 offset:24
    ds_read_b64_tr_b16 v[232:233], v197 offset:184
    ds_read_b64_tr_b16 v[234:235], v197 offset:344
    ds_read_b64_tr_b16 v[236:237], v197 offset:504
    ds_read_b64_tr_b16 v[238:239], v197 offset:664
    ds_read_b64_tr_b16 v[20:21], v197 offset:32
    ds_read_b64_tr_b16 v[22:23], v197 offset:192
    ds_read_b64_tr_b16 v[24:25], v197 offset:352
    ds_read_b64_tr_b16 v[26:27], v197 offset:512
    s_waitcnt lgkmcnt(14)
    ds_read_b64_tr_b16 v[28:29], v197 offset:672
    s_barrier
    s_branch m_cv_lo
m_kc6:
    s_cmp_eq_u32 s72, -1
    s_cbranch_scc1 m_cs18
    v_mov_b32 v8, 163820
    s_waitcnt vmcnt(0)
    s_mov_b64 exec, 1
    ds_add_rtn_u32 v9, v8, v12
    s_mov_b64 exec, -1
    s_waitcnt lgkmcnt(0)
    v_readfirstlane_b32 s12, v9
    s_nop 0
    s_and_b32 s12, s12, 3
    s_cmp_lg_u32 s12, 3
    s_cbranch_scc1 m_cs18
    s_mov_b32 s11, s72
    s_lshl_b32 s11, s11, 7
    s_mov_b64 exec, 1
    buffer_store_dword v12, v13, s[56:59], s11 offen sc1
    s_mov_b64 exec, -1
    s_mov_b32 s11, -1
m_cs18:
    s_mov_b32 s72, -1
    s_branch m_prep3
m_kv1:
    s_add_u32 s12, s8, s70
    s_lshl_b32 s12, s12, 4
    s_add_u32 s12, s12, s6
    s_mul_i32 s12, s12, 3456
    s_add_u32 s52, s46, 5242880
    s_addc_u32 s53, s47, 0
    s_add_u32 s52, s52, s12
    s_addc_u32 s53, s53, 0
    s_mov_b32 s54, 3360
    s_mov_b32 s55, 0x20000
    s_waitcnt lgkmcnt(0)
    s_barrier
    s_cmp_lg_u32 s3, 7
    s_cbranch_scc1 m_sg19
    s_cmp_eq_u32 s11, -1
    s_cbranch_scc1 m_sg19
    s_lshl_b32 s11, s11, 7
    s_mov_b64 exec, 1
    buffer_store_dword v12, v13, s[56:59], s11 offen sc1
    s_mov_b64 exec, -1
m_sg19:
    s_mov_b32 s11, -1
    ds_read_b64_tr_b16 v[164:165], v251 offset:0
    ds_read_b64_tr_b16 v[166:167], v251 offset:2816
    ds_read_b64_tr_b16 v[20:21], v250 offset:0
    ds_read_b64_tr_b16 v[22:23], v250 offset:5632
    ds_read_b64_tr_b16 v[24:25], v250 offset:32
    ds_read_b64_tr_b16 v[26:27], v250 offset:5664
    ds_read_b64_tr_b16 v[28:29], v250 offset:64
    ds_read_b64_tr_b16 v[30:31], v250 offset:5696
    ds_read_b64_tr_b16 v[168:169], v251 offset:5632
    ds_read_b64_tr_b16 v[170:171], v251 offset:8448
    ds_read_b64_tr_b16 v[32:33], v250 offset:11264
    ds_read_b64_tr_b16 v[34:35], v250 offset:16896
    ds_read_b64_tr_b16 v[36:37], v250 offset:11296
    ds_read_b64_tr_b16 v[38:39], v250 offset:16928
    ds_read_b64_tr_b16 v[40:41], v250 offset:11328
    ds_read_b64_tr_b16 v[42:43], v250 offset:16960
    ds_read_b64_tr_b16 v[172:173], v251 offset:11264
    ds_read_b64_tr_b16 v[174:175], v251 offset:14080
    ds_read_b64_tr_b16 v[44:45], v250 offset:22528
    ds_read_b64_tr_b16 v[46:47], v250 offset:28160
    ds_read_b64_tr_b16 v[48:49], v250 offset:22560
    ds_read_b64_tr_b16 v[50:51], v250 offset:28192
    ds_read_b64_tr_b16 v[52:53], v250 offset:22592
    ds_read_b64_tr_b16 v[54:55], v250 offset:28224
    ds_read_b64_tr_b16 v[176:177], v251 offset:16896
    ds_read_b64_tr_b16 v[178:179], v251 offset:19712
    ds_read_b64_tr_b16 v[56:57], v250 offset:33792
    ds_read_b64_tr_b16 v[58:59], v250 offset:39424
    ds_read_b64_tr_b16 v[60:61], v250 offset:33824
    ds_read_b64_tr_b16 v[62:63], v250 offset:39456
    ds_read_b64_tr_b16 v[64:65], v250 offset:33856
    ds_read_b64_tr_b16 v[66:67], v250 offset:39488
    s_cmp_lg_u32 s69, 0
    s_cbranch_scc1 m_kc5
    s_waitcnt vmcnt(0)
    v_readfirstlane_b32 s65, v15
    s_nop 0
    s_cmp_eq_u32 s65, 0
    s_cbranch_scc1 m_kc4
    v_cmp_ne_u32 vcc, 0, v15
    s_nop 0
    s_cmp_eq_u64 vcc, -1
    s_cbranch_scc1 m_cp20
    s_mov_b32 s71, 40000
m_poll21:
    buffer_load_dword v15, v14, s[56:59], 0 offen sc1
    s_waitcnt vmcnt(0)
    v_cmp_ne_u32 vcc, 0, v15
    s_nop 0
    s_cmp_eq_u64 vcc, -1
    s_cbranch_scc1 m_pd22
    s_sleep 8
    s_sub_u32 s71, s71, 1
    s_cmp_lg_u32 s71, 0
    s_cbranch_scc1 m_poll21
m_pd22:
m_cp20:
    v_mul_u32_u24 v8, 640, v4
    v_lshl_add_u32 v9, v3, 3, v8
    v_lshl_add_u32 v8, v3, 4, v8
    s_lshl_b32 s12, s4, 2
    s_and_b32 s13, s5, 3
    s_add_u32 s12, s12, s13
    s_mul_i32 s12, s12, 81920
    s_and_b32 s13, s5, 28
    s_add_u32 s13, s13, s70
    s_mul_i32 s13, s13, 2560
    s_add_u32 s12, s12, s13
    s_add_u32 s48, s46, 0
    s_addc_u32 s49, s47, 0
    s_add_u32 s48, s48, s12
    s_addc_u32 s49, s49, 0
    s_mov_b32 s50, 2560
    s_mov_b32 s51, 0x20000
    buffer_load_dwordx4 v[240:243], v8, s[48:51], 0 offen sc1
    buffer_load_dwordx4 v[244:247], v8, s[48:51], 0 offen offset:256 sc1
    s_waitcnt vmcnt(5)
    buffer_load_dwordx2 v[248:249], v9, s[48:51], 0 offen offset:512 sc1
    s_branch m_kc5
m_kc4:
    buffer_load_dword v15, v14, s[56:59], 0 offen sc1
m_kc5:
    s_waitcnt lgkmcnt(14)
    v_mfma_f32_16x16x32_bf16 v[144:147], v[20:23], v[164:167], 0
    v_mfma_f32_16x16x32_bf16 v[148:151], v[24:27], v[164:167], 0
    v_mfma_f32_16x16x32_bf16 v[152:155], v[28:31], v[164:167], 0
    v_mfma_f32_16x16x32_bf16 v[144:147], v[32:35], v[168:171], v[144:147]
    v_mfma_f32_16x16x32_bf16 v[148:151], v[36:39], v[168:171], v[148:151]
    v_mfma_f32_16x16x32_bf16 v[152:155], v[40:43], v[168:171], v[152:155]
    s_waitcnt lgkmcnt(12)
    v_mfma_f32_16x16x32_bf16 v[144:147], v[44:47], v[172:175], v[144:147]
    s_waitcnt lgkmcnt(10)
    v_mfma_f32_16x16x32_bf16 v[148:151], v[48:51], v[172:175], v[148:151]
    s_waitcnt lgkmcnt(8)
    v_mfma_f32_16x16x32_bf16 v[152:155], v[52:55], v[172:175], v[152:155]
    s_waitcnt lgkmcnt(4)
    v_mfma_f32_16x16x32_bf16 v[144:147], v[56:59], v[176:179], v[144:147]
    s_waitcnt lgkmcnt(2)
    v_mfma_f32_16x16x32_bf16 v[148:151], v[60:63], v[176:179], v[148:151]
    s_waitcnt lgkmcnt(0)
    v_mfma_f32_16x16x32_bf16 v[152:155], v[64:67], v[176:179], v[152:155]
    s_nop 3
    buffer_store_dwordx4 v[144:147], v252, s[52:55], 0 offen offset:0 sc1
    s_nop 0
    buffer_store_dwordx4 v[148:151], v252, s[52:55], 0 offen offset:1344 sc1
    s_nop 0
    buffer_store_dwordx4 v[152:155], v252, s[52:55], 0 offen offset:2688 sc1
    s_add_u32 s11, s2, 128
    s_cmp_eq_u32 s69, 0
    s_cbranch_scc1 m_kcopy2
    s_waitcnt vmcnt(3)
    s_branch m_conv
m_phi1z:
    s_waitcnt vmcnt(0)
m_phi1:
    s_lshl_b32 s12, s64, 2
    s_load_dwordx2 s[40:41], s[40:41], s12
    s_mov_b32 s68, 1
    s_add_u32 s64, s64, 1
    s_add_u32 s56, s46, 21037056
    s_addc_u32 s57, s47, 0
    s_mov_b32 s58, 65536
    s_mov_b32 s59, 0x20000
    s_mov_b32 s60, s44
    s_mov_b32 s61, s45
    s_mov_b32 s62, 256
    s_mov_b32 s63, 0x20000
    s_add_u32 s48, s46, 12582912
    s_addc_u32 s49, s47, 0
    s_mov_b32 s50, 2621440
    s_mov_b32 s51, 0x20000
    s_add_u32 s72, s6, 0
    s_mov_b32 s55, s54
m_ujob:
    v_lshl_add_u32 v8, v4, 2, v5
    v_lshlrev_b32 v8, 7, v8
    v_lshl_add_u32 v8, v6, 3, v8
    v_add_u32 v8, s55, v8
    v_mul_u32_u24 v9, 144, v3
    v_lshl_add_u32 v9, v4, 3, v9
    v_add_u32 v9, s55, v9
    ds_read_b64_tr_b16 v[144:145], v8 offset:0
    ds_read_b64_tr_b16 v[146:147], v8 offset:2048
    ds_read_b64_tr_b16 v[148:149], v8 offset:4096
    ds_read_b64_tr_b16 v[150:151], v8 offset:6144
    ds_read_b64_tr_b16 v[152:153], v8 offset:32
    ds_read_b64_tr_b16 v[154:155], v8 offset:2080
    ds_read_b64_tr_b16 v[156:157], v8 offset:4128
    ds_read_b64_tr_b16 v[158:159], v8 offset:6176
    ds_read_b64_tr_b16 v[160:161], v8 offset:64
    ds_read_b64_tr_b16 v[162:163], v8 offset:2112
    ds_read_b64_tr_b16 v[164:165], v8 offset:4160
    ds_read_b64_tr_b16 v[166:167], v8 offset:6208
    ds_read_b64_tr_b16 v[168:169], v8 offset:96
    ds_read_b64_tr_b16 v[170:171], v8 offset:2144
    ds_read_b64_tr_b16 v[172:173], v8 offset:4192
    ds_read_b64_tr_b16 v[174:175], v8 offset:6240
    s_waitcnt lgkmcnt(0)
    ds_write_b64 v9, v[144:145] offset:0
    ds_write_b64 v9, v[146:147] offset:32
    ds_write_b64 v9, v[148:149] offset:64
    ds_write_b64 v9, v[150:151] offset:96
    ds_write_b64 v9, v[152:153] offset:2304
    ds_write_b64 v9, v[154:155] offset:2336
    ds_write_b64 v9, v[156:157] offset:2368
    ds_write_b64 v9, v[158:159] offset:2400
    ds_write_b64 v9, v[160:161] offset:4608
    ds_write_b64 v9, v[162:163] offset:4640
    ds_write_b64 v9, v[164:165] offset:4672
    ds_write_b64 v9, v[166:167] offset:4704
    ds_write_b64 v9, v[168:169] offset:6912
    ds_write_b64 v9, v[170:171] offset:6944
    ds_write_b64 v9, v[172:173] offset:6976
    ds_write_b64 v9, v[174:175] offset:7008
    v_lshrrev_b32 v10, 3, v1
    v_and_b32 v9, 7, v1
    v_lshlrev_b32 v9, 4, v9
    v_mul_u32_u24 v8, 144, v10
    v_add3_u32 v8, v8, v9, s55
    v_lshl_add_u32 v9, v10, 12, v9
    s_lshr_b32 s12, s9, 5
    s_lshl_b32 s12, s12, 18
    s_and_b32 s13, s9, 31
    s_lshl_b32 s13, s13, 7
    s_add_u32 s12, s12, s13
    ds_read_b128 v[144:147], v8 offset:0
    ds_read_b128 v[148:151], v8 offset:1152
    ds_read_b128 v[152:155], v8 offset:2304
    ds_read_b128 v[156:159], v8 offset:3456
    ds_read_b128 v[160:163], v8 offset:4608
    ds_read_b128 v[164:167], v8 offset:5760
    ds_read_b128 v[168:171], v8 offset:6912
    ds_read_b128 v[172:175], v8 offset:8064
    s_waitcnt lgkmcnt(7)
    buffer_store_dwordx4 v[144:147], v9, s[48:51], s12 offen sc1
    s_add_u32 s12, s12, 32768
    s_waitcnt lgkmcnt(6)
    buffer_store_dwordx4 v[148:151], v9, s[48:51], s12 offen sc1
    s_add_u32 s12, s12, 32768
    s_waitcnt lgkmcnt(5)
    buffer_store_dwordx4 v[152:155], v9, s[48:51], s12 offen sc1
    s_add_u32 s12, s12, 32768
    s_waitcnt lgkmcnt(4)
    buffer_store_dwordx4 v[156:159], v9, s[48:51], s12 offen sc1
    s_add_u32 s12, s12, 32768
    s_waitcnt lgkmcnt(3)
    buffer_store_dwordx4 v[160:163], v9, s[48:51], s12 offen sc1
    s_add_u32 s12, s12, 32768
    s_waitcnt lgkmcnt(2)
    buffer_store_dwordx4 v[164:167], v9, s[48:51], s12 offen sc1
    s_add_u32 s12, s12, 32768
    s_waitcnt lgkmcnt(1)
    buffer_store_dwordx4 v[168:171], v9, s[48:51], s12 offen sc1
    s_add_u32 s12, s12, 32768
    s_waitcnt lgkmcnt(0)
    buffer_store_dwordx4 v[172:175], v9, s[48:51], s12 offen sc1
    s_add_u32 s12, s12, 32768
    s_cmp_lg_u32 s55, 20480
    s_cbranch_scc1 m_ujob2
    s_mov_b32 s55, 61440
    s_add_u32 s9, s9, 2
    s_branch m_ujob
m_ujob2:
    s_mov_b32 s71, 40000
m_poll23:
    buffer_load_dword v11, v255, s[60:63], 0 offen sc1
    s_waitcnt vmcnt(0)
    v_cmp_ne_u32 vcc, 0, v11
    s_nop 0
    s_cmp_eq_u64 vcc, -1
    s_cbranch_scc1 m_pd24
    s_sleep 8
    s_sub_u32 s71, s71, 1
    s_cmp_lg_u32 s71, 0
    s_cbranch_scc1 m_poll23
m_pd24:
    s_cmp_eq_u32 s72, -1
    s_cbranch_scc1 m_cs25
    v_mov_b32 v8, 163824
    s_waitcnt vmcnt(0)
    s_mov_b64 exec, 1
    ds_add_rtn_u32 v9, v8, v12
    s_mov_b64 exec, -1
    s_waitcnt lgkmcnt(0)
    v_readfirstlane_b32 s12, v9
    s_nop 0
    s_and_b32 s12, s12, 3
    s_cmp_lg_u32 s12, 3
    s_cbranch_scc1 m_cs25
    s_mov_b32 s11, s72
    s_lshl_b32 s11, s11, 7
    s_mov_b64 exec, 1
    buffer_store_dword v12, v13, s[56:59], s11 offen sc1
    s_mov_b64 exec, -1
    s_mov_b32 s11, -1
m_cs25:
    s_mov_b32 s72, -1
    s_cmp_ge_u32 s70, 2
    s_cbranch_scc1 m_phi1b
    s_cmp_ge_u32 s6, 40
    s_cbranch_scc1 m_phi1b
    v_lshl_add_u32 v8, v4, 3, v5
    v_mul_u32_u24 v8, 320, v8
    v_add_u32 v8, s54, v8
    v_lshl_add_u32 v8, v6, 3, v8
    s_lshl_b32 s12, s52, 1
    s_mul_i32 s12, s12, 102400
    s_mul_i32 s13, s53, 5120
    s_add_u32 s12, s12, s13
    s_add_u32 s13, s12, 102400
    s_add_u32 s14, s12, 4096
    s_add_u32 s15, s13, 4096
    s_add_u32 s48, s46, 20185088
    s_addc_u32 s49, s47, 0
    s_mov_b32 s50, 819200
    s_mov_b32 s51, 0x20000
    ds_read_b64_tr_b16 v[184:185], v8 offset:40960
    ds_read_b64_tr_b16 v[186:187], v8 offset:42240
    ds_read_b64_tr_b16 v[188:189], v8 offset:40992
    ds_read_b64_tr_b16 v[190:191], v8 offset:42272
    ds_read_b64_tr_b16 v[192:193], v8 offset:41024
    ds_read_b64_tr_b16 v[194:195], v8 offset:42304
    ds_read_b64_tr_b16 v[196:197], v8 offset:41056
    ds_read_b64_tr_b16 v[198:199], v8 offset:42336
    ds_read_b64_tr_b16 v[200:201], v8 offset:41088
    ds_read_b64_tr_b16 v[202:203], v8 offset:42368
    ds_read_b64_tr_b16 v[204:205], v8 offset:41120
    ds_read_b64_tr_b16 v[206:207], v8 offset:42400
    ds_read_b64_tr_b16 v[208:209], v8 offset:41152
    ds_read_b64_tr_b16 v[210:211], v8 offset:42432
    ds_read_b64_tr_b16 v[212:213], v8 offset:41184
    ds_read_b64_tr_b16 v[214:215], v8 offset:42464
    ds_read_b64_tr_b16 v[216:217], v8 offset:41216
    ds_read_b64_tr_b16 v[218:219], v8 offset:42496
    ds_read_b64_tr_b16 v[220:221], v8 offset:41248
    ds_read_b64_tr_b16 v[222:223], v8 offset:42528
    s_waitcnt lgkmcnt(14)
    buffer_store_dwordx4 v[184:187], v7, s[48:51], s12 offen offset:0 sc1
    buffer_store_dwordx4 v[188:191], v7, s[48:51], s12 offen offset:1024 sc1
    buffer_store_dwordx4 v[192:195], v7, s[48:51], s12 offen offset:2048 sc1
    s_waitcnt lgkmcnt(12)
    buffer_store_dwordx4 v[196:199], v7, s[48:51], s12 offen offset:3072 sc1
    s_waitcnt lgkmcnt(10)
    buffer_store_dwordx4 v[200:203], v7, s[48:51], s14 offen offset:0 sc1
    s_waitcnt lgkmcnt(8)
    buffer_store_dwordx4 v[204:207], v7, s[48:51], s13 offen offset:0 sc1
    s_waitcnt lgkmcnt(6)
    buffer_store_dwordx4 v[208:211], v7, s[48:51], s13 offen offset:1024 sc1
    s_waitcnt lgkmcnt(4)
    buffer_store_dwordx4 v[212:215], v7, s[48:51], s13 offen offset:2048 sc1
    s_waitcnt lgkmcnt(2)
    buffer_store_dwordx4 v[216:219], v7, s[48:51], s13 offen offset:3072 sc1
    s_waitcnt lgkmcnt(0)
    buffer_store_dwordx4 v[220:223], v7, s[48:51], s15 offen offset:0 sc1
m_phi1b:
    v_mov_b32 v136, -1
    v_mov_b32 v137, -1
    v_mov_b32 v138, -1
    v_mov_b32 v139, -1
    s_lshl_b32 s12, s4, 2
    s_and_b32 s13, s5, 3
    s_add_u32 s12, s12, s13
    s_lshr_b32 s13, s5, 2
    s_lshl_b32 s13, s13, 4
    s_lshl_b32 s14, s70, 2
    s_add_u32 s13, s13, s14
    s_mul_i32 s13, s13, 20480
    v_lshrrev_b32 v8, 5, v1
    v_mul_u32_u24 v8, 19968, v8
    v_add_u32 v8, v8, v7
    v_bfe_u32 v9, v1, 3, 2
    v_mul_u32_u24 v9, 20480, v9
    v_and_b32 v10, 7, v1
    v_lshl_add_u32 v9, v10, 4, v9
    s_lshl_b32 s14, s12, 9
    s_add_u32 s15, s14, 40960
    s_lshl_b32 s12, s12, 7
    s_add_u32 s12, s12, 16384
    s_add_u32 s48, s46, 7012352
    s_addc_u32 s49, s47, 0
    s_add_u32 s48, s48, s13
    s_addc_u32 s49, s49, 0
    s_mov_b32 s50, 81920
    s_mov_b32 s51, 0x20000
    buffer_store_dwordx4 v[136:139], v8, s[48:51], s14 offen sc1
    buffer_store_dwordx4 v[136:139], v8, s[48:51], s15 offen sc1
    buffer_store_dwordx4 v[136:139], v9, s[48:51], s12 offen sc1
    s_lshl_b32 s12, s64, 13
    s_lshl_b32 s13, s70, 12
    s_sub_u32 s12, s12, 8192
    s_add_u32 s48, s46, 9633792
    s_addc_u32 s49, s47, 0
    s_add_u32 s48, s48, s12
    s_addc_u32 s49, s49, 0
    s_mov_b32 s50, 16384
    s_mov_b32 s51, 0x20000
    buffer_store_dwordx4 v[136:139], v7, s[48:51], s13 offen offset:0 sc1
    buffer_store_dwordx4 v[136:139], v7, s[48:51], s13 offen offset:1024 sc1
    buffer_store_dwordx4 v[136:139], v7, s[48:51], s13 offen offset:2048 sc1
    buffer_store_dwordx4 v[136:139], v7, s[48:51], s13 offen offset:3072 sc1
    s_add_u32 s72, s6, 448
    s_cmp_eq_u32 s72, -1
    s_cbranch_scc1 m_cs26
    v_mov_b32 v8, 163816
    s_waitcnt vmcnt(0)
    s_mov_b64 exec, 1
    ds_add_rtn_u32 v9, v8, v12
    s_mov_b64 exec, -1
    s_waitcnt lgkmcnt(0)
    v_readfirstlane_b32 s12, v9
    s_nop 0
    s_and_b32 s12, s12, 3
    s_cmp_lg_u32 s12, 3
    s_cbranch_scc1 m_cs26
    s_mov_b32 s11, s72
    s_lshl_b32 s11, s11, 7
    s_mov_b64 exec, 1
    buffer_store_dword v12, v13, s[56:59], s11 offen sc1
    s_mov_b64 exec, -1
    s_mov_b32 s11, -1
m_cs26:
    s_mov_b32 s72, -1
    v_cmp_ne_u32 vcc, 0, v11
    s_nop 0
    s_cmp_eq_u64 vcc, -1
    s_cbranch_scc1 m_cp27
    s_mov_b32 s71, 40000
m_poll28:
    buffer_load_dword v11, v255, s[60:63], 0 offen sc1
    s_waitcnt vmcnt(0)
    v_cmp_ne_u32 vcc, 0, v11
    s_nop 0
    s_cmp_eq_u64 vcc, -1
    s_cbranch_scc1 m_pd29
    s_sleep 4
    s_sub_u32 s71, s71, 1
    s_cmp_lg_u32 s71, 0
    s_cbranch_scc1 m_poll28
m_pd29:
m_cp27:
    s_lshr_b32 s12, s64, 5
    s_lshl_b32 s12, s12, 5
    s_lshl_b32 s13, s70, 3
    s_add_u32 s12, s12, s13
    v_and_b32 v9, 7, v1
    v_add_u32 v8, s12, v9
    v_mul_u32_u24 v8, 13108, v8
    v_lshrrev_b32 v8, 16, v8
    v_add_u32 v14, 0, v8
    v_lshlrev_b32 v14, 7, v14
    buffer_load_dword v15, v14, s[56:59], 0 offen sc1
    s_waitcnt vmcnt(0)
    v_cmp_ne_u32 vcc, 0, v15
    s_nop 0
    s_cmp_eq_u64 vcc, -1
    s_cbranch_scc1 m_cp30
    s_mov_b32 s71, 40000
m_poll31:
    buffer_load_dword v15, v14, s[56:59], 0 offen sc1
    s_waitcnt vmcnt(0)
    v_cmp_ne_u32 vcc, 0, v15
    s_nop 0
    s_cmp_eq_u64 vcc, -1
    s_cbranch_scc1 m_pd32
    s_sleep 4
    s_sub_u32 s71, s71, 1
    s_cmp_lg_u32 s71, 0
    s_cbranch_scc1 m_poll31
m_pd32:
m_cp30:
    s_lshl_b32 s12, s64, 13
    s_lshl_b32 s13, s70, 10
    s_add_u32 s14, s13, 4096
    s_add_u32 s48, s46, 12582912
    s_addc_u32 s49, s47, 0
    s_add_u32 s48, s48, s12
    s_addc_u32 s49, s49, 0
    s_mov_b32 s50, 8192
    s_mov_b32 s51, 0x20000
    s_sub_u32 s15, s13, s74
    s_add_u32 m0, s15, 155104
    s_nop 0
    buffer_load_dwordx4 v7, s[48:51], s13 offen sc1 lds
    s_add_u32 m0, s15, 159712
    s_nop 0
    buffer_load_dwordx4 v7, s[48:51], s14 offen sc1 lds
    s_mov_b32 s74, 43392
    s_sub_u32 s64, s64, 1
    s_mov_b32 s55, 16
    v_mov_b32 v8, 163812
m_lb33:
    ds_read_b32 v9, v8
    s_waitcnt lgkmcnt(0)
    v_readfirstlane_b32 s12, v9
    s_nop 0
    s_cmp_lt_u32 s12, s55
    s_cbranch_scc1 m_lb33
    v_cmp_ne_u32 vcc, 0, v15
    s_nop 0
    s_cmp_eq_u64 vcc, -1
    s_cbranch_scc1 m_cp34
    s_mov_b32 s71, 40000
m_poll35:
    buffer_load_dword v15, v14, s[56:59], 0 offen sc1
    s_waitcnt vmcnt(0)
    v_cmp_ne_u32 vcc, 0, v15
    s_nop 0
    s_cmp_eq_u64 vcc, -1
    s_cbranch_scc1 m_pd36
    s_sleep 4
    s_sub_u32 s71, s71, 1
    s_cmp_lg_u32 s71, 0
    s_cbranch_scc1 m_poll35
m_pd36:
m_cp34:
    s_lshl_b32 s12, s64, 13
    s_lshl_b32 s13, s70, 10
    s_add_u32 s14, s13, 4096
    s_add_u32 s48, s46, 12582912
    s_addc_u32 s49, s47, 0
    s_add_u32 s48, s48, s12
    s_addc_u32 s49, s49, 0
    s_mov_b32 s50, 8192
    s_mov_b32 s51, 0x20000
    s_sub_u32 s15, s13, s74
    s_add_u32 m0, s15, 155104
    s_nop 0
    buffer_load_dwordx4 v7, s[48:51], s13 offen sc1 lds
    s_add_u32 m0, s15, 159712
    s_nop 0
    buffer_load_dwordx4 v7, s[48:51], s14 offen sc1 lds
m_prep3:
    s_mov_b32 s65, 0
    s_setprio 0
    s_lshr_b32 s12, s70, 1
    s_mul_i32 s14, s12, 16704
    s_add_u32 s14, s14, 121280
    s_mul_i32 s15, s12, 4608
    s_add_u32 s15, s15, 154624
    v_sub_u32 v8, 15, v3
    v_and_b32 v9, 3, v8
    v_mul_u32_u24 v208, 4160, v9
    v_lshrrev_b32 v8, 2, v8
    v_lshl_add_u32 v208, v8, 3, v208
    v_lshl_add_u32 v208, v4, 4, v208
    s_and_b32 s12, s70, 1
    s_lshl_b32 s12, s12, 8
    s_sub_u32 s12, s12, s74
    s_add_u32 s13, s12, s14
    v_add_u32 v208, s13, v208
    v_lshlrev_b32 v209, 5, v3
    v_lshl_add_u32 v209, v4, 4, v209
    s_add_u32 s13, s12, s15
    v_add_u32 v209, s13, v209
    s_and_b32 s12, s4, 3
    s_lshl_b32 s12, s12, 5
    s_lshr_b32 s13, s4, 2
    s_add_u32 s12, s12, s13
    s_add_u32 s12, s12, 256
    v_lshl_add_u32 v253, v6, 3, s12
    v_lshl_add_u32 v253, v5, 1, v253
    s_lshr_b32 s13, s5, 3
    s_mul_i32 s13, s13, 10
    s_add_u32 s13, s13, 448
    v_min_u32 v8, 9, v3
    v_cmp_le_u32 vcc, 32, v1
    v_add_u32 v8, s13, v8
    v_lshlrev_b32 v11, 7, v8
    v_cndmask_b32 v253, v253, v8, vcc
    v_lshlrev_b32 v253, 7, v253
    s_cmp_lg_u32 s69, 0
    s_cselect_b64 vcc, -1, 0
    s_lshr_b32 s12, s5, 2
    s_lshl_b32 s12, s12, 1
    s_lshr_b32 s13, s70, 1
    s_add_u32 s12, s12, s13
    s_and_b32 s13, s12, 3
    s_lshl_b32 s13, s13, 3
    s_lshr_b32 s12, s12, 2
    s_lshl_b32 s12, s12, 1
    s_add_u32 s12, s12, s13
    s_lshr_b32 s13, s4, 2
    s_add_u32 s12, s12, s13
    s_bfe_u32 s13, s4, 65537
    s_lshl_b32 s13, s13, 5
    s_add_u32 s12, s12, s13
    s_add_u32 s12, s12, 64
    s_lshl_b32 s12, s12, 7
    v_mov_b32 v8, s12
    v_cndmask_b32 v14, v8, v14, vcc
    s_cmp_lg_u32 s69, 0
    s_cbranch_scc1 m_prep4
    s_waitcnt vmcnt(0)
    buffer_load_dword v15, v14, s[56:59], 0 offen sc1
    s_branch m_conv
m_prep4:
    s_waitcnt vmcnt(0)
m_conv:
    s_waitcnt lgkmcnt(14)
    v_mov_b32 v30, v208
    v_mov_b32 v31, v209
m_conv_b:
    s_waitcnt lgkmcnt(0)
    s_barrier
    .p2align 2
    s_cmp_eq_u32 s69, 0
    s_cbranch_scc1 m_cv_lo
    s_cmp_lg_u32 s3, 7
    s_cbranch_scc1 m_sg37
    s_cmp_eq_u32 s11, -1
    s_cbranch_scc1 m_sg37
    s_lshl_b32 s11, s11, 7
    s_mov_b64 exec, 1
    buffer_store_dword v12, v13, s[56:59], s11 offen sc1
    s_mov_b64 exec, -1
m_sg37:
    s_mov_b32 s11, -1
    s_lshl_b32 s8, s4, 2
    s_and_b32 s12, s5, 3
    s_add_u32 s8, s8, s12
    s_lshr_b32 s9, s5, 2
    s_lshr_b32 s10, s5, 2
    s_lshl_b32 s73, s10, 1
    s_mul_i32 s12, s10, 102400
    s_add_u32 s52, s46, 20185088
    s_addc_u32 s53, s47, 0
    s_add_u32 s52, s52, s12
    s_addc_u32 s53, s53, 0
    s_mov_b32 s54, 102400
    s_mov_b32 s55, 0x20000
    .p2align 2
    s_mov_b32 s65, 0
    s_cmp_eq_u32 s68, 1
    s_cbranch_scc1 m_cv_h0
    v_cmp_ne_u32 vcc, 0, v254
    s_nop 0
    s_cmp_lg_u32 vcc_hi, -1
    s_cbranch_scc1 m_cv_h0
    s_mov_b32 s65, 1
    s_add_u32 s15, s70, 0
    s_xor_b32 s13, s15, s73
    s_mul_i32 s13, s13, 5120
    s_mul_i32 s15, s15, 5120
    s_add_u32 m0, s15, 0
    s_nop 0
    buffer_load_dwordx4 v7, s[52:55], s13 offen offset:0 sc1 lds
    buffer_load_dwordx4 v7, s[52:55], s13 offen offset:1024 sc1 lds
    buffer_load_dwordx4 v7, s[52:55], s13 offen offset:2048 sc1 lds
    buffer_load_dwordx4 v7, s[52:55], s13 offen offset:3072 sc1 lds
    s_add_u32 m0, s15, 4096
    s_add_u32 s13, s13, 4096
    buffer_load_dwordx4 v7, s[52:55], s13 offen sc1 lds
    s_add_u32 s15, s70, 4
    s_xor_b32 s13, s15, s73
    s_mul_i32 s13, s13, 5120
    s_mul_i32 s15, s15, 5120
    s_add_u32 m0, s15, 0
    s_nop 0
    buffer_load_dwordx4 v7, s[52:55], s13 offen offset:0 sc1 lds
    buffer_load_dwordx4 v7, s[52:55], s13 offen offset:1024 sc1 lds
    buffer_load_dwordx4 v7, s[52:55], s13 offen offset:2048 sc1 lds
    buffer_load_dwordx4 v7, s[52:55], s13 offen offset:3072 sc1 lds
    s_add_u32 m0, s15, 4096
    s_add_u32 s13, s13, 4096
    buffer_load_dwordx4 v7, s[52:55], s13 offen sc1 lds
m_cv_h0:
    ds_read_b128 v[164:167], v31 offset:0
    ds_read_b64 v[132:133], v30 offset:3584
    ds_read_b64 v[134:135], v30 offset:3592
    ds_read_b128 v[168:171], v31 offset:512
    ds_read_b64 v[136:137], v30 offset:3072
    ds_read_b64 v[138:139], v30 offset:3080
    ds_read_b128 v[172:175], v31 offset:1024
    ds_read_b64 v[140:141], v30 offset:2560
    ds_read_b64 v[142:143], v30 offset:2568
    s_waitcnt lgkmcnt(6)
    v_mfma_f32_16x16x32_bf16 v[36:39], v[132:135], v[164:167], 0
    ds_read_b128 v[176:179], v31 offset:1536
    ds_read_b64 v[144:145], v30 offset:2048
    s_waitcnt lgkmcnt(7)
    v_mfma_f32_16x16x32_bf16 v[40:43], v[132:135], v[168:171], 0
    ds_read_b64 v[146:147], v30 offset:2056
    ds_read_b128 v[180:183], v31 offset:2048
    s_waitcnt lgkmcnt(7)
    v_mfma_f32_16x16x32_bf16 v[40:43], v[136:139], v[164:167], v[40:43]
    ds_read_b64 v[148:149], v30 offset:1536
    ds_read_b64 v[150:151], v30 offset:1544
    v_mfma_f32_16x16x32_bf16 v[44:47], v[136:139], v[168:171], 0
    ds_read_b128 v[184:187], v31 offset:2560
    ds_read_b64 v[152:153], v30 offset:1024
    s_waitcnt lgkmcnt(10)
    v_mfma_f32_16x16x32_bf16 v[44:47], v[132:135], v[172:175], v[44:47]
    ds_read_b64 v[154:155], v30 offset:1032
    ds_read_b128 v[188:191], v31 offset:3072
    v_mfma_f32_16x16x32_bf16 v[48:51], v[136:139], v[172:175], 0
    ds_read_b64 v[156:157], v30 offset:512
    ds_read_b64 v[158:159], v30 offset:520
    s_waitcnt lgkmcnt(12)
    v_mfma_f32_16x16x32_bf16 v[44:47], v[140:143], v[164:167], v[44:47]
    ds_read_b128 v[192:195], v31 offset:3584
    ds_read_b64 v[160:161], v30 offset:0
    v_mfma_f32_16x16x32_bf16 v[48:51], v[140:143], v[168:171], v[48:51]
    ds_read_b64 v[162:163], v30 offset:8
    ds_read_b128 v[100:103], v31 offset:64
    v_mfma_f32_16x16x32_bf16 v[52:55], v[140:143], v[172:175], 0
    ds_read_b64 v[68:69], v30 offset:3648
    ds_read_b64 v[70:71], v30 offset:3656
    s_waitcnt lgkmcnt(14)
    v_mfma_f32_16x16x32_bf16 v[48:51], v[132:135], v[176:179], v[48:51]
    ds_read_b128 v[104:107], v31 offset:576
    ds_read_b64 v[72:73], v30 offset:3136
    v_mfma_f32_16x16x32_bf16 v[52:55], v[136:139], v[176:179], v[52:55]
    ds_read_b64 v[74:75], v30 offset:3144
    ds_read_b128 v[108:111], v31 offset:1088
    v_mfma_f32_16x16x32_bf16 v[56:59], v[140:143], v[176:179], 0
    ds_read_b64 v[76:77], v30 offset:2624
    v_mfma_f32_16x16x32_bf16 v[48:51], v[144:147], v[164:167], v[48:51]
    ds_read_b64 v[78:79], v30 offset:2632
    v_mfma_f32_16x16x32_bf16 v[52:55], v[144:147], v[168:171], v[52:55]
    ds_read_b128 v[112:115], v31 offset:1600
    v_mfma_f32_16x16x32_bf16 v[56:59], v[144:147], v[172:175], v[56:59]
    ds_read_b64 v[80:81], v30 offset:2112
    v_mfma_f32_16x16x32_bf16 v[60:63], v[144:147], v[176:179], 0
    ds_read_b64 v[82:83], v30 offset:2120
    v_mfma_f32_16x16x32_bf16 v[52:55], v[132:135], v[180:183], v[52:55]
    ds_read_b128 v[116:119], v31 offset:2112
    v_mfma_f32_16x16x32_bf16 v[56:59], v[136:139], v[180:183], v[56:59]
    ds_read_b64 v[84:85], v30 offset:1600
    v_mfma_f32_16x16x32_bf16 v[60:63], v[140:143], v[180:183], v[60:63]
    ds_read_b64 v[86:87], v30 offset:1608
    v_mfma_f32_16x16x32_bf16 v[64:67], v[144:147], v[180:183], 0
    ds_read_b128 v[120:123], v31 offset:2624
    s_waitcnt lgkmcnt(14)
    v_mfma_f32_16x16x32_bf16 v[52:55], v[148:151], v[164:167], v[52:55]
    ds_read_b64 v[88:89], v30 offset:1088
    v_mfma_f32_16x16x32_bf16 v[56:59], v[148:151], v[168:171], v[56:59]
    ds_read_b64 v[90:91], v30 offset:1096
    v_mfma_f32_16x16x32_bf16 v[60:63], v[148:151], v[172:175], v[60:63]
    ds_read_b128 v[124:127], v31 offset:3136
    v_mfma_f32_16x16x32_bf16 v[64:67], v[148:151], v[176:179], v[64:67]
    ds_read_b64 v[92:93], v30 offset:576
    v_mfma_f32_16x16x32_bf16 v[56:59], v[132:135], v[184:187], v[56:59]
    ds_read_b64 v[94:95], v30 offset:584
    v_mfma_f32_16x16x32_bf16 v[60:63], v[136:139], v[184:187], v[60:63]
    ds_read_b128 v[128:131], v31 offset:3648
    v_mfma_f32_16x16x32_bf16 v[64:67], v[140:143], v[184:187], v[64:67]
    ds_read_b64 v[96:97], v30 offset:64
    v_mfma_f32_16x16x32_bf16 v[56:59], v[152:155], v[164:167], v[56:59]
    ds_read_b64 v[98:99], v30 offset:72
    v_mfma_f32_16x16x32_bf16 v[60:63], v[152:155], v[168:171], v[60:63]
    v_mul_u32_u24 v17, 320, v4
    v_lshl_add_u32 v17, v3, 4, v17
    v_mfma_f32_16x16x32_bf16 v[64:67], v[152:155], v[172:175], v[64:67]
    s_mul_i32 s12, s70, 9728
    s_sub_u32 s12, s12, s74
    v_mfma_f32_16x16x32_bf16 v[60:63], v[132:135], v[188:191], v[60:63]
    s_add_u32 s12, s12, 121216
    v_add_u32 v17, s12, v17
    v_mfma_f32_16x16x32_bf16 v[64:67], v[136:139], v[188:191], v[64:67]
    s_lshl_b32 s15, s70, 10
    s_sub_u32 s15, s15, s74
    v_mfma_f32_16x16x32_bf16 v[60:63], v[156:159], v[164:167], v[60:63]
    s_add_u32 s15, s15, 155104
    v_add_u32 v10, s15, v7
    v_mfma_f32_16x16x32_bf16 v[64:67], v[156:159], v[168:171], v[64:67]
    ds_read_b128 v[20:23], v10
    ds_read_b128 v[24:27], v10 offset:4608
    v_mfma_f32_16x16x32_bf16 v[64:67], v[132:135], v[192:195], v[64:67]
    s_mul_i32 s13, s10, 40
    v_min_u32 v8, 39, v1
    v_mfma_f32_16x16x32_bf16 v[64:67], v[160:163], v[164:167], v[64:67]
    v_add_u32 v8, s13, v8
    v_add_u32 v9, 192, v8
    s_waitcnt lgkmcnt(14)
    v_mfma_f32_16x16x32_bf16 v[36:39], v[68:71], v[100:103], v[36:39]
    ds_read_b128 v[164:167], v31 offset:128
    v_mfma_f32_16x16x32_bf16 v[40:43], v[68:71], v[104:107], v[40:43]
    ds_read_b64 v[132:133], v30 offset:3712
    v_mfma_f32_16x16x32_bf16 v[40:43], v[72:75], v[100:103], v[40:43]
    ds_read_b64 v[134:135], v30 offset:3720
    v_mfma_f32_16x16x32_bf16 v[44:47], v[72:75], v[104:107], v[44:47]
    ds_read_b128 v[168:171], v31 offset:640
    v_mfma_f32_16x16x32_bf16 v[44:47], v[68:71], v[108:111], v[44:47]
    ds_read_b64 v[136:137], v30 offset:3200
    v_mfma_f32_16x16x32_bf16 v[48:51], v[72:75], v[108:111], v[48:51]
    ds_read_b64 v[138:139], v30 offset:3208
    v_mfma_f32_16x16x32_bf16 v[44:47], v[76:79], v[100:103], v[44:47]
    ds_read_b128 v[172:175], v31 offset:1152
    v_mfma_f32_16x16x32_bf16 v[48:51], v[76:79], v[104:107], v[48:51]
    ds_read_b64 v[140:141], v30 offset:2688
    v_mfma_f32_16x16x32_bf16 v[52:55], v[76:79], v[108:111], v[52:55]
    ds_read_b64 v[142:143], v30 offset:2696
    v_mfma_f32_16x16x32_bf16 v[48:51], v[68:71], v[112:115], v[48:51]
    ds_read_b128 v[176:179], v31 offset:1664
    v_mfma_f32_16x16x32_bf16 v[52:55], v[72:75], v[112:115], v[52:55]
    ds_read_b64 v[144:145], v30 offset:2176
    v_mfma_f32_16x16x32_bf16 v[56:59], v[76:79], v[112:115], v[56:59]
    ds_read_b64 v[146:147], v30 offset:2184
    v_mfma_f32_16x16x32_bf16 v[48:51], v[80:83], v[100:103], v[48:51]
    ds_read_b128 v[180:183], v31 offset:2176
    v_mfma_f32_16x16x32_bf16 v[52:55], v[80:83], v[104:107], v[52:55]
    ds_read_b64 v[148:149], v30 offset:1664
    v_mfma_f32_16x16x32_bf16 v[56:59], v[80:83], v[108:111], v[56:59]
    ds_read_b64 v[150:151], v30 offset:1672
    v_mfma_f32_16x16x32_bf16 v[60:63], v[80:83], v[112:115], v[60:63]
    ds_read_b128 v[184:187], v31 offset:2688
    s_waitcnt lgkmcnt(14)
    v_mfma_f32_16x16x32_bf16 v[52:55], v[68:71], v[116:119], v[52:55]
    ds_read_b64 v[152:153], v30 offset:1152
    v_mfma_f32_16x16x32_bf16 v[56:59], v[72:75], v[116:119], v[56:59]
    ds_read_b64 v[154:155], v30 offset:1160
    v_mfma_f32_16x16x32_bf16 v[60:63], v[76:79], v[116:119], v[60:63]
    ds_read_b128 v[188:191], v31 offset:3200
    v_mfma_f32_16x16x32_bf16 v[64:67], v[80:83], v[116:119], v[64:67]
    ds_read_b64 v[156:157], v30 offset:640
    v_mfma_f32_16x16x32_bf16 v[52:55], v[84:87], v[100:103], v[52:55]
    ds_read_b64 v[158:159], v30 offset:648
    v_mfma_f32_16x16x32_bf16 v[56:59], v[84:87], v[104:107], v[56:59]
    ds_read_b128 v[192:195], v31 offset:3712
    v_mfma_f32_16x16x32_bf16 v[60:63], v[84:87], v[108:111], v[60:63]
    ds_read_b64 v[160:161], v30 offset:128
    v_mfma_f32_16x16x32_bf16 v[64:67], v[84:87], v[112:115], v[64:67]
    ds_read_b64 v[162:163], v30 offset:136
    v_mfma_f32_16x16x32_bf16 v[56:59], v[68:71], v[120:123], v[56:59]
    v_lshrrev_b32 v9, 1, v9
    v_min_u32 v8, v8, v9
    v_mfma_f32_16x16x32_bf16 v[60:63], v[72:75], v[120:123], v[60:63]
    s_lshl_b32 s13, s4, 5
    v_and_b32 v9, 31, v1
    v_mfma_f32_16x16x32_bf16 v[64:67], v[76:79], v[120:123], v[64:67]
    v_add_u32 v9, s13, v9
    s_cmp_eq_u32 s3, 4
    v_mfma_f32_16x16x32_bf16 v[56:59], v[88:91], v[100:103], v[56:59]
    s_cselect_b64 vcc, -1, 0
    v_cndmask_b32 v8, v8, v9, vcc
    v_mfma_f32_16x16x32_bf16 v[60:63], v[88:91], v[104:107], v[60:63]
    v_add_u32 v8, 256, v8
    v_lshlrev_b32 v14, 7, v8
    v_mfma_f32_16x16x32_bf16 v[64:67], v[88:91], v[108:111], v[64:67]
    v_and_b32 v8, 1, v1
    v_mul_u32_u24 v18, 640, v8
    v_mfma_f32_16x16x32_bf16 v[60:63], v[68:71], v[124:127], v[60:63]
    v_bfe_u32 v8, v1, 1, 4
    v_lshl_add_u32 v18, v8, 4, v18
    v_mfma_f32_16x16x32_bf16 v[64:67], v[72:75], v[124:127], v[64:67]
    v_lshrrev_b32 v8, 5, v1
    v_mul_u32_u24 v8, 1216, v8
    v_mfma_f32_16x16x32_bf16 v[60:63], v[92:95], v[100:103], v[60:63]
    s_mul_i32 s12, s70, 2432
    s_sub_u32 s12, s12, s74
    v_mfma_f32_16x16x32_bf16 v[64:67], v[92:95], v[104:107], v[64:67]
    s_add_u32 s12, s12, 121216
    v_add3_u32 v18, v18, v8, s12
    v_mfma_f32_16x16x32_bf16 v[64:67], v[68:71], v[128:131], v[64:67]
    s_lshl_b32 s13, s64, 13
    s_lshl_b32 s14, s40, 16
    v_mfma_f32_16x16x32_bf16 v[64:67], v[96:99], v[100:103], v[64:67]
    s_and_b32 s15, s40, 0xffff0000
    s_mov_b32 s40, s41
    s_waitcnt lgkmcnt(14)
    v_mfma_f32_16x16x32_bf16 v[36:39], v[132:135], v[164:167], v[36:39]
    ds_read_b128 v[100:103], v31 offset:192
    v_mfma_f32_16x16x32_bf16 v[40:43], v[132:135], v[168:171], v[40:43]
    ds_read_b64 v[68:69], v30 offset:3776
    v_mfma_f32_16x16x32_bf16 v[40:43], v[136:139], v[164:167], v[40:43]
    ds_read_b64 v[70:71], v30 offset:3784
    v_mfma_f32_16x16x32_bf16 v[44:47], v[136:139], v[168:171], v[44:47]
    ds_read_b128 v[104:107], v31 offset:704
    v_mfma_f32_16x16x32_bf16 v[44:47], v[132:135], v[172:175], v[44:47]
    ds_read_b64 v[72:73], v30 offset:3264
    v_mfma_f32_16x16x32_bf16 v[48:51], v[136:139], v[172:175], v[48:51]
    ds_read_b64 v[74:75], v30 offset:3272
    v_mfma_f32_16x16x32_bf16 v[44:47], v[140:143], v[164:167], v[44:47]
    ds_read_b128 v[108:111], v31 offset:1216
    v_mfma_f32_16x16x32_bf16 v[48:51], v[140:143], v[168:171], v[48:51]
    ds_read_b64 v[76:77], v30 offset:2752
    v_mfma_f32_16x16x32_bf16 v[52:55], v[140:143], v[172:175], v[52:55]
    ds_read_b64 v[78:79], v30 offset:2760
    v_mfma_f32_16x16x32_bf16 v[48:51], v[132:135], v[176:179], v[48:51]
    ds_read_b128 v[112:115], v31 offset:1728
    v_mfma_f32_16x16x32_bf16 v[52:55], v[136:139], v[176:179], v[52:55]
    ds_read_b64 v[80:81], v30 offset:2240
    v_mfma_f32_16x16x32_bf16 v[56:59], v[140:143], v[176:179], v[56:59]
    ds_read_b64 v[82:83], v30 offset:2248
    s_cmp_eq_u32 s65, 0
    s_cbranch_scc1 m_cv_hm
    s_add_u32 s49, s70, 8
    s_xor_b32 s48, s49, s73
    s_mul_i32 s48, s48, 5120
    s_mul_i32 s49, s49, 5120
    s_add_u32 m0, s49, 0
    s_nop 0
    buffer_load_dwordx4 v7, s[52:55], s48 offen offset:0 sc1 lds
    buffer_load_dwordx4 v7, s[52:55], s48 offen offset:1024 sc1 lds
    buffer_load_dwordx4 v7, s[52:55], s48 offen offset:2048 sc1 lds
    buffer_load_dwordx4 v7, s[52:55], s48 offen offset:3072 sc1 lds
    s_add_u32 m0, s49, 4096
    s_add_u32 s48, s48, 4096
    buffer_load_dwordx4 v7, s[52:55], s48 offen sc1 lds
m_cv_hm:
    s_waitcnt lgkmcnt(14)
    v_mfma_f32_16x16x32_bf16 v[48:51], v[144:147], v[164:167], v[48:51]
    ds_read_b128 v[116:119], v31 offset:2240
    v_mfma_f32_16x16x32_bf16 v[52:55], v[144:147], v[168:171], v[52:55]
    ds_read_b64 v[84:85], v30 offset:1728
    v_mfma_f32_16x16x32_bf16 v[56:59], v[144:147], v[172:175], v[56:59]
    ds_read_b64 v[86:87], v30 offset:1736
    v_mfma_f32_16x16x32_bf16 v[60:63], v[144:147], v[176:179], v[60:63]
    ds_read_b128 v[120:123], v31 offset:2752
    v_mfma_f32_16x16x32_bf16 v[52:55], v[132:135], v[180:183], v[52:55]
    ds_read_b64 v[88:89], v30 offset:1216
    v_mfma_f32_16x16x32_bf16 v[56:59], v[136:139], v[180:183], v[56:59]
    ds_read_b64 v[90:91], v30 offset:1224
    v_mfma_f32_16x16x32_bf16 v[60:63], v[140:143], v[180:183], v[60:63]
    ds_read_b128 v[124:127], v31 offset:3264
    v_mfma_f32_16x16x32_bf16 v[64:67], v[144:147], v[180:183], v[64:67]
    ds_read_b64 v[92:93], v30 offset:704
    v_mfma_f32_16x16x32_bf16 v[52:55], v[148:151], v[164:167], v[52:55]
    ds_read_b64 v[94:95], v30 offset:712
    v_mfma_f32_16x16x32_bf16 v[56:59], v[148:151], v[168:171], v[56:59]
    ds_read_b128 v[128:131], v31 offset:3776
    v_mfma_f32_16x16x32_bf16 v[60:63], v[148:151], v[172:175], v[60:63]
    ds_read_b64 v[96:97], v30 offset:192
    v_mfma_f32_16x16x32_bf16 v[64:67], v[148:151], v[176:179], v[64:67]
    ds_read_b64 v[98:99], v30 offset:200
    v_mfma_f32_16x16x32_bf16 v[56:59], v[132:135], v[184:187], v[56:59]
    s_add_u32 s60, s46, 9633792
    s_addc_u32 s61, s47, 0
    v_mfma_f32_16x16x32_bf16 v[60:63], v[136:139], v[184:187], v[60:63]
    s_add_u32 s60, s60, s13
    s_addc_u32 s61, s61, 0
    v_mfma_f32_16x16x32_bf16 v[64:67], v[140:143], v[184:187], v[64:67]
    s_mov_b32 s62, 8192
    s_mov_b32 s63, 0x20000
    v_mfma_f32_16x16x32_bf16 v[56:59], v[152:155], v[164:167], v[56:59]
    v_lshlrev_b32 v8, 16, v20
    v_and_b32 v9, 0xffff0000, v20
    .p2align 2
    .p2align 2
    buffer_load_dword v32, v11, s[56:59], 0 offen sc1
    buffer_load_dword v15, v14, s[56:59], 0 offen sc1
    v_mfma_f32_16x16x32_bf16 v[60:63], v[152:155], v[168:171], v[60:63]
    v_mul_f32 v8, s14, v8
    v_mul_f32 v9, s14, v9
    v_mfma_f32_16x16x32_bf16 v[64:67], v[152:155], v[172:175], v[64:67]
    v_cvt_pk_bf16_f32 v20, v8, v9
    v_lshlrev_b32 v8, 16, v21
    v_mfma_f32_16x16x32_bf16 v[60:63], v[132:135], v[188:191], v[60:63]
    v_and_b32 v9, 0xffff0000, v21
    v_mul_f32 v8, s14, v8
    v_mfma_f32_16x16x32_bf16 v[64:67], v[136:139], v[188:191], v[64:67]
    v_mul_f32 v9, s14, v9
    v_cvt_pk_bf16_f32 v21, v8, v9
    v_mfma_f32_16x16x32_bf16 v[60:63], v[156:159], v[164:167], v[60:63]
    v_lshlrev_b32 v8, 16, v22
    v_and_b32 v9, 0xffff0000, v22
    v_mfma_f32_16x16x32_bf16 v[64:67], v[156:159], v[168:171], v[64:67]
    v_mul_f32 v8, s14, v8
    v_mul_f32 v9, s14, v9
    v_mfma_f32_16x16x32_bf16 v[64:67], v[132:135], v[192:195], v[64:67]
    v_cvt_pk_bf16_f32 v22, v8, v9
    v_lshlrev_b32 v8, 16, v23
    s_waitcnt lgkmcnt(14)
    v_mfma_f32_16x16x32_bf16 v[64:67], v[160:163], v[164:167], v[64:67]
    v_and_b32 v9, 0xffff0000, v23
    v_mul_f32 v8, s14, v8
    v_mov_b32 v254, 163832
    s_waitcnt lgkmcnt(0)
    s_mov_b64 exec, 1
    ds_add_u32 v254, v12
    s_mov_b64 exec, -1
    s_nop 0
    v_mfma_f32_16x16x32_bf16 v[64:67], v[68:71], v[128:131], v[64:67]
    v_mul_f32 v9, s14, v9
    v_cvt_pk_bf16_f32 v23, v8, v9
    v_mfma_f32_16x16x32_bf16 v[64:67], v[72:75], v[124:127], v[64:67]
    v_lshlrev_b32 v8, 16, v24
    v_and_b32 v9, 0xffff0000, v24
    v_mfma_f32_16x16x32_bf16 v[64:67], v[76:79], v[120:123], v[64:67]
    v_mul_f32 v8, s15, v8
    v_mul_f32 v9, s15, v9
    v_mfma_f32_16x16x32_bf16 v[64:67], v[80:83], v[116:119], v[64:67]
    v_cvt_pk_bf16_f32 v24, v8, v9
    v_lshlrev_b32 v8, 16, v25
    v_mfma_f32_16x16x32_bf16 v[64:67], v[84:87], v[112:115], v[64:67]
    v_and_b32 v9, 0xffff0000, v25
    v_mul_f32 v8, s15, v8
    v_mfma_f32_16x16x32_bf16 v[64:67], v[88:91], v[108:111], v[64:67]
    v_mul_f32 v9, s15, v9
    v_cvt_pk_bf16_f32 v25, v8, v9
    v_mfma_f32_16x16x32_bf16 v[64:67], v[92:95], v[104:107], v[64:67]
    v_lshlrev_b32 v8, 16, v26
    v_and_b32 v9, 0xffff0000, v26
    v_mfma_f32_16x16x32_bf16 v[64:67], v[96:99], v[100:103], v[64:67]
    v_mul_f32 v8, s15, v8
    v_mul_f32 v9, s15, v9
    v_mfma_f32_16x16x32_bf16 v[60:63], v[68:71], v[124:127], v[60:63]
    v_cvt_pk_bf16_f32 v26, v8, v9
    v_lshlrev_b32 v8, 16, v27
    v_mfma_f32_16x16x32_bf16 v[60:63], v[72:75], v[120:123], v[60:63]
    v_and_b32 v9, 0xffff0000, v27
    v_mul_f32 v8, s15, v8
    v_mfma_f32_16x16x32_bf16 v[60:63], v[76:79], v[116:119], v[60:63]
    v_mul_f32 v9, s15, v9
    v_cvt_pk_bf16_f32 v27, v8, v9
    s_lshr_b32 s71, s68, 1
    s_lshl_b32 s71, s71, 2
    s_add_u32 s71, s71, 4
    v_mov_b32 v254, 163832
m_dw38:
    ds_read_b32 v255, v254
    s_waitcnt lgkmcnt(0)
    v_readfirstlane_b32 s11, v255
    s_nop 0
    s_cmp_ge_u32 s11, s71
    s_cbranch_scc1 m_dd39
    s_sleep 1
    s_branch m_dw38
m_dd39:
    s_mov_b32 s11, -1
    v_mfma_f32_16x16x32_bf16 v[60:63], v[80:83], v[112:115], v[60:63]
    ds_write_b128 v17, v[64:67] offset:8512
    v_mfma_f32_16x16x32_bf16 v[60:63], v[84:87], v[108:111], v[60:63]
    v_mfma_f32_16x16x32_bf16 v[60:63], v[88:91], v[104:107], v[60:63]
    v_mfma_f32_16x16x32_bf16 v[60:63], v[92:95], v[100:103], v[60:63]
    v_mfma_f32_16x16x32_bf16 v[56:59], v[68:71], v[120:123], v[56:59]
    v_mfma_f32_16x16x32_bf16 v[56:59], v[72:75], v[116:119], v[56:59]
    v_mfma_f32_16x16x32_bf16 v[56:59], v[76:79], v[112:115], v[56:59]
    v_mfma_f32_16x16x32_bf16 v[56:59], v[80:83], v[108:111], v[56:59]
    s_nop 3
    ds_write_b128 v17, v[60:63] offset:7296
    v_mfma_f32_16x16x32_bf16 v[56:59], v[84:87], v[104:107], v[56:59]
    v_mfma_f32_16x16x32_bf16 v[56:59], v[88:91], v[100:103], v[56:59]
    v_mfma_f32_16x16x32_bf16 v[52:55], v[68:71], v[116:119], v[52:55]
    v_mfma_f32_16x16x32_bf16 v[52:55], v[72:75], v[112:115], v[52:55]
    v_mfma_f32_16x16x32_bf16 v[52:55], v[76:79], v[108:111], v[52:55]
    v_mfma_f32_16x16x32_bf16 v[52:55], v[80:83], v[104:107], v[52:55]
    s_nop 3
    ds_write_b128 v17, v[56:59] offset:6080
    v_mfma_f32_16x16x32_bf16 v[52:55], v[84:87], v[100:103], v[52:55]
    v_mfma_f32_16x16x32_bf16 v[48:51], v[68:71], v[112:115], v[48:51]
    v_mfma_f32_16x16x32_bf16 v[48:51], v[72:75], v[108:111], v[48:51]
    v_mfma_f32_16x16x32_bf16 v[48:51], v[76:79], v[104:107], v[48:51]
    v_mfma_f32_16x16x32_bf16 v[48:51], v[80:83], v[100:103], v[48:51]
    s_nop 3
    ds_write_b128 v17, v[52:55] offset:4864
    v_mfma_f32_16x16x32_bf16 v[44:47], v[68:71], v[108:111], v[44:47]
    v_mfma_f32_16x16x32_bf16 v[44:47], v[72:75], v[104:107], v[44:47]
    v_mfma_f32_16x16x32_bf16 v[44:47], v[76:79], v[100:103], v[44:47]
    v_mfma_f32_16x16x32_bf16 v[40:43], v[68:71], v[104:107], v[40:43]
    ds_write_b128 v17, v[48:51] offset:3648
    v_mfma_f32_16x16x32_bf16 v[40:43], v[72:75], v[100:103], v[40:43]
    v_mfma_f32_16x16x32_bf16 v[36:39], v[68:71], v[100:103], v[36:39]
    s_nop 3
    ds_write_b128 v17, v[44:47] offset:2432
    s_nop 1
    ds_write_b128 v17, v[40:43] offset:1216
    ds_write_b128 v17, v[36:39] offset:0
    v_mov_b32 v8, 163828
    s_waitcnt lgkmcnt(0)
    s_mov_b64 exec, 1
    ds_add_u32 v8, v12
    s_mov_b64 exec, -1
    s_lshr_b32 s71, s68, 1
    s_lshl_b32 s71, s71, 2
    s_add_u32 s71, s71, 4
    v_mov_b32 v254, 163828
m_dw40:
    ds_read_b32 v255, v254
    s_waitcnt lgkmcnt(0)
    v_readfirstlane_b32 s11, v255
    s_nop 0
    s_cmp_ge_u32 s11, s71
    s_cbranch_scc1 m_dd41
    s_sleep 1
    s_branch m_dw40
m_dd41:
    s_mov_b32 s11, -1
    ds_read_b128 v[68:71], v18 offset:0
    ds_read_b128 v[72:75], v18 offset:320
    ds_read_b128 v[76:79], v18 offset:9728
    ds_read_b128 v[80:83], v18 offset:10048
    ds_read_b128 v[100:103], v18 offset:19456
    ds_read_b128 v[104:107], v18 offset:19776
    ds_read_b128 v[108:111], v18 offset:29184
    ds_read_b128 v[112:115], v18 offset:29504
    s_lshl_b32 s12, s70, 10
    s_add_u32 s13, s12, 4096
    s_waitcnt lgkmcnt(5)
    v_pk_add_f32 v[68:69], v[68:69], v[76:77]
    v_pk_add_f32 v[70:71], v[70:71], v[78:79]
    s_waitcnt lgkmcnt(4)
    v_pk_add_f32 v[72:73], v[72:73], v[80:81]
    v_pk_add_f32 v[74:75], v[74:75], v[82:83]
    v_cvt_pk_bf16_f32 v76, v68, v69
    v_lshlrev_b32 v84, 16, v20
    v_and_b32 v85, 0xffff0000, v20
    v_lshlrev_b32 v86, 16, v76
    v_and_b32 v87, 0xffff0000, v76
    v_pk_add_f32 v[84:85], v[84:85], v[86:87]
    v_cvt_pk_bf16_f32 v76, v84, v85
    v_cvt_pk_bf16_f32 v77, v70, v71
    v_lshlrev_b32 v88, 16, v21
    v_and_b32 v89, 0xffff0000, v21
    v_lshlrev_b32 v90, 16, v77
    v_and_b32 v91, 0xffff0000, v77
    v_pk_add_f32 v[88:89], v[88:89], v[90:91]
    v_cvt_pk_bf16_f32 v77, v88, v89
    v_cvt_pk_bf16_f32 v78, v72, v73
    v_lshlrev_b32 v92, 16, v22
    v_and_b32 v93, 0xffff0000, v22
    v_lshlrev_b32 v94, 16, v78
    v_and_b32 v95, 0xffff0000, v78
    v_pk_add_f32 v[92:93], v[92:93], v[94:95]
    v_cvt_pk_bf16_f32 v78, v92, v93
    v_cvt_pk_bf16_f32 v79, v74, v75
    v_lshlrev_b32 v96, 16, v23
    v_and_b32 v97, 0xffff0000, v23
    v_lshlrev_b32 v98, 16, v79
    v_and_b32 v99, 0xffff0000, v79
    v_pk_add_f32 v[96:97], v[96:97], v[98:99]
    v_cvt_pk_bf16_f32 v79, v96, v97
    buffer_store_dwordx4 v[76:79], v7, s[60:63], s12 offen sc1
    s_waitcnt lgkmcnt(1)
    v_pk_add_f32 v[100:101], v[100:101], v[108:109]
    v_pk_add_f32 v[102:103], v[102:103], v[110:111]
    s_waitcnt lgkmcnt(0)
    v_pk_add_f32 v[104:105], v[104:105], v[112:113]
    v_pk_add_f32 v[106:107], v[106:107], v[114:115]
    v_cvt_pk_bf16_f32 v108, v100, v101
    v_lshlrev_b32 v116, 16, v24
    v_and_b32 v117, 0xffff0000, v24
    v_lshlrev_b32 v118, 16, v108
    v_and_b32 v119, 0xffff0000, v108
    v_pk_add_f32 v[116:117], v[116:117], v[118:119]
    v_cvt_pk_bf16_f32 v108, v116, v117
    v_cvt_pk_bf16_f32 v109, v102, v103
    v_lshlrev_b32 v120, 16, v25
    v_and_b32 v121, 0xffff0000, v25
    v_lshlrev_b32 v122, 16, v109
    v_and_b32 v123, 0xffff0000, v109
    v_pk_add_f32 v[120:121], v[120:121], v[122:123]
    v_cvt_pk_bf16_f32 v109, v120, v121
    v_cvt_pk_bf16_f32 v110, v104, v105
    v_lshlrev_b32 v124, 16, v26
    v_and_b32 v125, 0xffff0000, v26
    v_lshlrev_b32 v126, 16, v110
    v_and_b32 v127, 0xffff0000, v110
    v_pk_add_f32 v[124:125], v[124:125], v[126:127]
    v_cvt_pk_bf16_f32 v110, v124, v125
    v_cvt_pk_bf16_f32 v111, v106, v107
    v_lshlrev_b32 v128, 16, v27
    v_and_b32 v129, 0xffff0000, v27
    v_lshlrev_b32 v130, 16, v111
    v_and_b32 v131, 0xffff0000, v111
    v_pk_add_f32 v[128:129], v[128:129], v[130:131]
    v_cvt_pk_bf16_f32 v111, v128, v129
    buffer_store_dwordx4 v[108:111], v7, s[60:63], s13 offen sc1
    s_cmp_lg_u32 s68, 1
    s_cbranch_scc1 m_cv_h1
    s_waitcnt vmcnt(3)
    v_mov_b32 v254, v32
    s_mov_b32 s68, 2
    s_mov_b32 s74, 0
    s_add_u32 s64, s64, 1
    v_add_u32 v30, 43392, v30
    v_add_u32 v31, 43392, v31
    s_branch m_conv_b
m_cv_h1:
    s_cmp_ge_u32 s3, 6
    s_cbranch_scc1 m_cv_h2
    s_waitcnt vmcnt(2)
    v_cmp_ne_u32 vcc, 0, v15
    s_nop 0
    s_cmp_eq_u64 vcc, -1
    s_cbranch_scc1 m_cp42
    s_mov_b32 s71, 40000
m_poll43:
    buffer_load_dword v15, v14, s[56:59], 0 offen sc1
    s_waitcnt vmcnt(0)
    v_cmp_ne_u32 vcc, 0, v15
    s_nop 0
    s_cmp_eq_u64 vcc, -1
    s_cbranch_scc1 m_pd44
    s_sleep 8
    s_sub_u32 s71, s71, 1
    s_cmp_lg_u32 s71, 0
    s_cbranch_scc1 m_poll43
m_pd44:
m_cp42:
m_cv_h2:
    s_cmp_lg_u32 s65, 0
    s_cbranch_scc1 m_cv_h3
    s_waitcnt vmcnt(3)
    v_cmp_ne_u32 vcc, 0, v32
    s_nop 0
    s_cmp_eq_u64 vcc, -1
    s_cbranch_scc1 m_cp45
    s_mov_b32 s71, 40000
m_poll46:
    buffer_load_dword v32, v11, s[56:59], 0 offen sc1
    s_waitcnt vmcnt(0)
    v_cmp_ne_u32 vcc, 0, v32
    s_nop 0
    s_cmp_eq_u64 vcc, -1
    s_cbranch_scc1 m_pd47
    s_sleep 4
    s_sub_u32 s71, s71, 1
    s_cmp_lg_u32 s71, 0
    s_cbranch_scc1 m_poll46
m_pd47:
m_cp45:
    s_add_u32 s15, s70, 0
    s_xor_b32 s13, s15, s73
    s_mul_i32 s13, s13, 5120
    s_mul_i32 s15, s15, 5120
    s_add_u32 m0, s15, 0
    s_nop 0
    buffer_load_dwordx4 v7, s[52:55], s13 offen offset:0 sc1 lds
    buffer_load_dwordx4 v7, s[52:55], s13 offen offset:1024 sc1 lds
    buffer_load_dwordx4 v7, s[52:55], s13 offen offset:2048 sc1 lds
    buffer_load_dwordx4 v7, s[52:55], s13 offen offset:3072 sc1 lds
    s_add_u32 m0, s15, 4096
    s_add_u32 s13, s13, 4096
    buffer_load_dwordx4 v7, s[52:55], s13 offen sc1 lds
    s_add_u32 s15, s70, 4
    s_xor_b32 s13, s15, s73
    s_mul_i32 s13, s13, 5120
    s_mul_i32 s15, s15, 5120
    s_add_u32 m0, s15, 0
    s_nop 0
    buffer_load_dwordx4 v7, s[52:55], s13 offen offset:0 sc1 lds
    buffer_load_dwordx4 v7, s[52:55], s13 offen offset:1024 sc1 lds
    buffer_load_dwordx4 v7, s[52:55], s13 offen offset:2048 sc1 lds
    buffer_load_dwordx4 v7, s[52:55], s13 offen offset:3072 sc1 lds
    s_add_u32 m0, s15, 4096
    s_add_u32 s13, s13, 4096
    buffer_load_dwordx4 v7, s[52:55], s13 offen sc1 lds
    s_add_u32 s15, s70, 8
    s_xor_b32 s13, s15, s73
    s_mul_i32 s13, s13, 5120
    s_mul_i32 s15, s15, 5120
    s_add_u32 m0, s15, 0
    s_nop 0
    buffer_load_dwordx4 v7, s[52:55], s13 offen offset:0 sc1 lds
    buffer_load_dwordx4 v7, s[52:55], s13 offen offset:1024 sc1 lds
    buffer_load_dwordx4 v7, s[52:55], s13 offen offset:2048 sc1 lds
    buffer_load_dwordx4 v7, s[52:55], s13 offen offset:3072 sc1 lds
    s_add_u32 m0, s15, 4096
    s_add_u32 s13, s13, 4096
    buffer_load_dwordx4 v7, s[52:55], s13 offen sc1 lds
m_cv_h3:
    s_branch m_cv2
m_cv_lo:
    s_setprio 2
    s_mov_b32 s11, -1
    s_cmp_lg_u32 s68, 1
    s_cbranch_scc1 m_cv_l1
    s_lshl_b32 s12, s4, 2
    s_and_b32 s13, s5, 3
    s_add_u32 s12, s12, s13
    s_mul_i32 s12, s12, 800
    s_and_b32 s13, s70, 1
    s_lshl_b32 s13, s13, 10
    v_add_u32 v8, s13, v7
    s_add_u32 s48, s20, s12
    s_addc_u32 s49, s21, 0
    s_mov_b32 s50, 800
    s_mov_b32 s51, 0x20000
    s_add_u32 m0, s13, 71680
    s_nop 0
    buffer_load_dwordx4 v8, s[48:51], 0 offen lds
    s_waitcnt vmcnt(0)
m_cv_lw:
    s_lshr_b32 s71, s68, 1
    s_lshl_b32 s71, s71, 2
    s_add_u32 s71, s71, 4
    v_mov_b32 v254, 163832
m_dw48:
    ds_read_b32 v255, v254
    s_waitcnt lgkmcnt(0)
    v_readfirstlane_b32 s11, v255
    s_nop 0
    s_cmp_ge_u32 s11, s71
    s_cbranch_scc1 m_dd49
    s_sleep 1
    s_branch m_dw48
m_dd49:
    s_mov_b32 s11, -1
    buffer_load_dword v15, v14, s[56:59], 0 offen sc1
    s_mov_b32 s68, 2
    s_mov_b32 s74, 0
    s_add_u32 s64, s64, 1
    v_add_u32 v30, 43392, v30
    v_add_u32 v31, 43392, v31
    s_branch m_conv_b
m_cv_l1:
    s_cmp_lg_u32 s65, 0
    s_cbranch_scc1 m_cv_l3
    s_waitcnt vmcnt(0)
    v_cmp_ne_u32 vcc, 0, v15
    s_nop 0
    s_cmp_eq_u64 vcc, -1
    s_cbranch_scc1 m_cp50
    s_mov_b32 s71, 40000
m_poll51:
    buffer_load_dword v15, v14, s[56:59], 0 offen sc1
    s_waitcnt vmcnt(0)
    v_cmp_ne_u32 vcc, 0, v15
    s_nop 0
    s_cmp_eq_u64 vcc, -1
    s_cbranch_scc1 m_pd52
    s_sleep 8
    s_sub_u32 s71, s71, 1
    s_cmp_lg_u32 s71, 0
    s_cbranch_scc1 m_poll51
m_pd52:
m_cp50:
    v_mul_u32_u24 v8, 640, v4
    v_lshl_add_u32 v9, v3, 3, v8
    v_lshl_add_u32 v8, v3, 4, v8
    s_lshl_b32 s12, s4, 2
    s_and_b32 s13, s5, 3
    s_add_u32 s12, s12, s13
    s_mul_i32 s12, s12, 81920
    s_and_b32 s13, s5, 28
    s_add_u32 s13, s13, s70
    s_mul_i32 s13, s13, 2560
    s_add_u32 s12, s12, s13
    s_add_u32 s48, s46, 0
    s_addc_u32 s49, s47, 0
    s_add_u32 s48, s48, s12
    s_addc_u32 s49, s49, 0
    s_mov_b32 s50, 2560
    s_mov_b32 s51, 0x20000
    buffer_load_dwordx4 v[240:243], v8, s[48:51], 0 offen sc1
    buffer_load_dwordx4 v[244:247], v8, s[48:51], 0 offen offset:256 sc1
    buffer_load_dwordx2 v[248:249], v9, s[48:51], 0 offen offset:512 sc1
m_cv_l3:
    s_mov_b32 s72, 4000
    s_cmp_lt_u32 s7, 4
    s_cbranch_scc1 m_cv_l4
    v_mul_u32_u24 v8, 40, v5
    v_mov_b32 v197, 1024
    v_cmp_eq_u32 vcc, v6, v4
    s_nop 1
    v_cndmask_b32 v197, v197, v8, vcc
    v_add_u32 v197, 71680, v197
    s_waitcnt lgkmcnt(14)
    ds_read_b64_tr_b16 v[200:201], v197 offset:0
    ds_read_b64_tr_b16 v[202:203], v197 offset:160
    ds_read_b64_tr_b16 v[204:205], v197 offset:320
    ds_read_b64_tr_b16 v[206:207], v197 offset:480
    ds_read_b64_tr_b16 v[208:209], v197 offset:640
    ds_read_b64_tr_b16 v[210:211], v197 offset:8
    ds_read_b64_tr_b16 v[212:213], v197 offset:168
    ds_read_b64_tr_b16 v[214:215], v197 offset:328
    ds_read_b64_tr_b16 v[216:217], v197 offset:488
    ds_read_b64_tr_b16 v[218:219], v197 offset:648
    ds_read_b64_tr_b16 v[220:221], v197 offset:16
    s_waitcnt lgkmcnt(14)
    ds_read_b64_tr_b16 v[222:223], v197 offset:176
    ds_read_b64_tr_b16 v[224:225], v197 offset:336
    ds_read_b64_tr_b16 v[226:227], v197 offset:496
    ds_read_b64_tr_b16 v[228:229], v197 offset:656
    ds_read_b64_tr_b16 v[230:231], v197 offset:24
    ds_read_b64_tr_b16 v[232:233], v197 offset:184
    ds_read_b64_tr_b16 v[234:235], v197 offset:344
    ds_read_b64_tr_b16 v[236:237], v197 offset:504
    ds_read_b64_tr_b16 v[238:239], v197 offset:664
    ds_read_b64_tr_b16 v[20:21], v197 offset:32
    ds_read_b64_tr_b16 v[22:23], v197 offset:192
    s_waitcnt lgkmcnt(14)
    ds_read_b64_tr_b16 v[24:25], v197 offset:352
    ds_read_b64_tr_b16 v[26:27], v197 offset:512
    ds_read_b64_tr_b16 v[28:29], v197 offset:672
m_cv_l4:
    s_cmp_lg_u32 s65, 0
    s_cbranch_scc1 m_cv_l5
    s_waitcnt vmcnt(0)
m_cv_l5:
    s_waitcnt vmcnt(3)
    .p2align 2
    .p2align 2
    buffer_load_dword v254, v253, s[56:59], 0 offen sc1
    s_lshl_b32 s8, s4, 2
    s_and_b32 s12, s5, 3
    s_add_u32 s8, s8, s12
    s_waitcnt lgkmcnt(14)
    v_mfma_f32_16x16x32_bf16 v[76:79], v[200:203], v[240:243], 0
    s_lshr_b32 s9, s5, 2
    s_lshr_b32 s10, s5, 2
    s_lshl_b32 s73, s10, 1
    v_mfma_f32_16x16x32_bf16 v[80:83], v[210:213], v[240:243], 0
    s_mul_i32 s1, s70, 5120
    s_add_u32 s1, s1, 81920
    s_mul_i32 s14, s10, 102400
    s_waitcnt lgkmcnt(13)
    v_mfma_f32_16x16x32_bf16 v[84:87], v[220:223], v[240:243], 0
    s_mul_i32 s12, s8, 55296
    s_lshl_b32 s0, s9, 1
    v_mov_b32 v9, 0x100000
    s_waitcnt lgkmcnt(8)
    v_mfma_f32_16x16x32_bf16 v[88:91], v[230:233], v[240:243], 0
    v_cmp_gt_u32 vcc, 210, v0
    v_lshlrev_b32 v8, 4, v0
    v_mul_u32_u24 v19, 1280, v4
    s_waitcnt lgkmcnt(3)
    v_mfma_f32_16x16x32_bf16 v[92:95], v[20:23], v[240:243], 0
    v_cndmask_b32 v16, v9, v8, vcc
    v_add_u32 v19, s1, v19
    v_lshl_add_u32 v33, v3, 4, v19
    v_mfma_f32_16x16x32_bf16 v[76:79], v[204:207], v[244:247], v[76:79]
    v_lshl_add_u32 v19, v3, 3, v19
    v_lshlrev_b32 v10, 3, v0
    v_add_u32 v10, 102400, v10
    v_mfma_f32_16x16x32_bf16 v[80:83], v[214:217], v[244:247], v[80:83]
    s_add_u32 s48, s46, 20185088
    s_addc_u32 s49, s47, 0
    s_add_u32 s48, s48, s14
    v_mfma_f32_16x16x32_bf16 v[84:87], v[224:227], v[244:247], v[84:87]
    s_addc_u32 s49, s49, 0
    s_mov_b32 s50, 102400
    s_mov_b32 s51, 0x20000
    v_mfma_f32_16x16x32_bf16 v[88:91], v[234:237], v[244:247], v[88:91]
    s_add_u32 s52, s46, 5242880
    s_addc_u32 s53, s47, 0
    s_add_u32 s52, s52, s12
    s_waitcnt lgkmcnt(1)
    v_mfma_f32_16x16x32_bf16 v[92:95], v[24:27], v[244:247], v[92:95]
    s_addc_u32 s53, s53, 0
    s_mov_b32 s54, 55296
    s_mov_b32 s55, 0x20000
    v_mfma_f32_16x16x16_bf16 v[76:79], v[208:209], v[248:249], v[76:79]
    v_mfma_f32_16x16x16_bf16 v[80:83], v[218:219], v[248:249], v[80:83]
    v_mfma_f32_16x16x16_bf16 v[84:87], v[228:229], v[248:249], v[84:87]
    v_mfma_f32_16x16x16_bf16 v[88:91], v[238:239], v[248:249], v[88:91]
    s_waitcnt lgkmcnt(0)
    v_mfma_f32_16x16x16_bf16 v[92:95], v[28:29], v[248:249], v[92:95]
    s_nop 2
    v_max3_f32 v116, v76, v77, v78
    v_min3_f32 v118, v76, v77, v78
    v_max3_f32 v116, v116, v79, v80
    v_min3_f32 v118, v118, v79, v80
    v_max3_f32 v116, v116, v81, v82
    v_min3_f32 v118, v118, v81, v82
    v_max3_f32 v116, v116, v83, v84
    v_min3_f32 v118, v118, v83, v84
    v_max3_f32 v116, v116, v85, v86
    v_min3_f32 v118, v118, v85, v86
    v_max3_f32 v116, v116, v87, v88
    v_min3_f32 v118, v118, v87, v88
    v_max3_f32 v116, v116, v89, v90
    v_min3_f32 v118, v118, v89, v90
    v_max3_f32 v116, v116, v91, v92
    v_min3_f32 v118, v118, v91, v92
    v_max3_f32 v116, v116, v93, v94
    v_min3_f32 v118, v118, v93, v94
    v_max_f32 v116, v116, v95
    v_min_f32 v118, v118, v95
    v_mul_f32_e64 v116, -v116, s66
    v_mul_f32 v118, s66, v118
    v_fma_f32 v36, v76, s66, v116
    v_fma_f32 v56, -v76, s66, v118
    v_fma_f32 v37, v77, s66, v116
    s_waitcnt vmcnt(0)
    v_cmp_ne_u32 vcc, 0, v254
    s_nop 0
    s_cmp_eq_u64 vcc, -1
    s_cselect_b32 s54, s54, 0
    s_xor_b32 s13, s0, 0
    s_mul_i32 s13, s13, 3456
    buffer_load_dwordx4 v[132:135], v16, s[52:55], s13 offen sc1
    v_fma_f32 v57, -v77, s66, v118
    v_exp_f32 v36, v36
    v_exp_f32 v56, v56
    s_xor_b32 s13, s0, 1
    s_mul_i32 s13, s13, 3456
    buffer_load_dwordx4 v[136:139], v16, s[52:55], s13 offen sc1
    v_fma_f32 v38, v78, s66, v116
    v_fma_f32 v58, -v78, s66, v118
    v_exp_f32 v37, v37
    s_xor_b32 s13, s0, 2
    s_mul_i32 s13, s13, 3456
    buffer_load_dwordx4 v[140:143], v16, s[52:55], s13 offen sc1
    v_exp_f32 v57, v57
    v_fma_f32 v39, v79, s66, v116
    v_fma_f32 v59, -v79, s66, v118
    s_xor_b32 s13, s0, 3
    s_mul_i32 s13, s13, 3456
    buffer_load_dwordx4 v[144:147], v16, s[52:55], s13 offen sc1
    v_exp_f32 v38, v38
    v_exp_f32 v58, v58
    v_add_f32 v117, v36, v37
    s_xor_b32 s13, s0, 4
    s_mul_i32 s13, s13, 3456
    buffer_load_dwordx4 v[148:151], v16, s[52:55], s13 offen sc1
    v_add_f32 v119, v56, v57
    v_fma_f32 v40, v80, s66, v116
    v_fma_f32 v60, -v80, s66, v118
    s_xor_b32 s13, s0, 5
    s_mul_i32 s13, s13, 3456
    buffer_load_dwordx4 v[152:155], v16, s[52:55], s13 offen sc1
    v_exp_f32 v39, v39
    v_exp_f32 v59, v59
    v_add_f32 v117, v117, v38
    s_xor_b32 s13, s0, 6
    s_mul_i32 s13, s13, 3456
    buffer_load_dwordx4 v[156:159], v16, s[52:55], s13 offen sc1
    v_add_f32 v119, v119, v58
    v_fma_f32 v41, v81, s66, v116
    v_fma_f32 v61, -v81, s66, v118
    s_xor_b32 s13, s0, 7
    s_mul_i32 s13, s13, 3456
    buffer_load_dwordx4 v[160:163], v16, s[52:55], s13 offen sc1
    v_exp_f32 v40, v40
    v_exp_f32 v60, v60
    v_add_f32 v117, v117, v39
    s_xor_b32 s13, s0, 8
    s_mul_i32 s13, s13, 3456
    buffer_load_dwordx4 v[164:167], v16, s[52:55], s13 offen sc1
    v_add_f32 v119, v119, v59
    v_fma_f32 v42, v82, s66, v116
    v_fma_f32 v62, -v82, s66, v118
    s_xor_b32 s13, s0, 9
    s_mul_i32 s13, s13, 3456
    buffer_load_dwordx4 v[168:171], v16, s[52:55], s13 offen sc1
    v_exp_f32 v41, v41
    v_exp_f32 v61, v61
    v_add_f32 v117, v117, v40
    s_xor_b32 s13, s0, 10
    s_mul_i32 s13, s13, 3456
    buffer_load_dwordx4 v[172:175], v16, s[52:55], s13 offen sc1
    v_add_f32 v119, v119, v60
    v_fma_f32 v43, v83, s66, v116
    v_fma_f32 v63, -v83, s66, v118
    s_xor_b32 s13, s0, 11
    s_mul_i32 s13, s13, 3456
    buffer_load_dwordx4 v[176:179], v16, s[52:55], s13 offen sc1
    v_exp_f32 v42, v42
    v_exp_f32 v62, v62
    v_add_f32 v117, v117, v41
    s_xor_b32 s13, s0, 12
    s_mul_i32 s13, s13, 3456
    buffer_load_dwordx4 v[180:183], v16, s[52:55], s13 offen sc1
    v_add_f32 v119, v119, v61
    v_fma_f32 v44, v84, s66, v116
    v_fma_f32 v64, -v84, s66, v118
    s_xor_b32 s13, s0, 13
    s_mul_i32 s13, s13, 3456
    buffer_load_dwordx4 v[184:187], v16, s[52:55], s13 offen sc1
    v_exp_f32 v43, v43
    v_exp_f32 v63, v63
    v_add_f32 v117, v117, v42
    s_xor_b32 s13, s0, 14
    s_mul_i32 s13, s13, 3456
    buffer_load_dwordx4 v[188:191], v16, s[52:55], s13 offen sc1
    v_add_f32 v119, v119, v62
    v_fma_f32 v45, v85, s66, v116
    v_fma_f32 v65, -v85, s66, v118
    s_xor_b32 s13, s0, 15
    s_mul_i32 s13, s13, 3456
    buffer_load_dwordx4 v[192:195], v16, s[52:55], s13 offen sc1
    v_exp_f32 v44, v44
    v_exp_f32 v64, v64
    v_add_f32 v117, v117, v43
    v_add_f32 v119, v119, v63
    v_fma_f32 v46, v86, s66, v116
    v_fma_f32 v66, -v86, s66, v118
    v_exp_f32 v45, v45
    v_exp_f32 v65, v65
    v_add_f32 v117, v117, v44
    v_add_f32 v119, v119, v64
    v_fma_f32 v47, v87, s66, v116
    v_fma_f32 v67, -v87, s66, v118
    v_exp_f32 v46, v46
    v_exp_f32 v66, v66
    v_add_f32 v117, v117, v45
    v_add_f32 v119, v119, v65
    v_fma_f32 v48, v88, s66, v116
    v_fma_f32 v68, -v88, s66, v118
    v_exp_f32 v47, v47
    v_exp_f32 v67, v67
    v_add_f32 v117, v117, v46
    v_add_f32 v119, v119, v66
    v_fma_f32 v49, v89, s66, v116
    v_fma_f32 v69, -v89, s66, v118
    v_exp_f32 v48, v48
    v_exp_f32 v68, v68
    v_add_f32 v117, v117, v47
    v_add_f32 v119, v119, v67
    v_fma_f32 v50, v90, s66, v116
    v_fma_f32 v70, -v90, s66, v118
    v_exp_f32 v49, v49
    v_exp_f32 v69, v69
    v_add_f32 v117, v117, v48
    v_add_f32 v119, v119, v68
    v_fma_f32 v51, v91, s66, v116
    v_fma_f32 v71, -v91, s66, v118
    v_exp_f32 v50, v50
    v_exp_f32 v70, v70
    v_add_f32 v117, v117, v49
    v_add_f32 v119, v119, v69
    v_fma_f32 v52, v92, s66, v116
    v_fma_f32 v72, -v92, s66, v118
    v_exp_f32 v51, v51
    v_exp_f32 v71, v71
    v_add_f32 v117, v117, v50
    v_add_f32 v119, v119, v70
    v_fma_f32 v53, v93, s66, v116
    v_fma_f32 v73, -v93, s66, v118
    v_exp_f32 v52, v52
    v_exp_f32 v72, v72
    v_add_f32 v117, v117, v51
    v_add_f32 v119, v119, v71
    v_fma_f32 v54, v94, s66, v116
    v_fma_f32 v74, -v94, s66, v118
    v_exp_f32 v53, v53
    v_exp_f32 v73, v73
    v_add_f32 v117, v117, v52
    v_add_f32 v119, v119, v72
    v_fma_f32 v55, v95, s66, v116
    v_fma_f32 v75, -v95, s66, v118
    v_exp_f32 v54, v54
    v_exp_f32 v74, v74
    v_add_f32 v117, v117, v53
    v_add_f32 v119, v119, v73
    v_exp_f32 v55, v55
    v_exp_f32 v75, v75
    v_add_f32 v117, v117, v54
    v_add_f32 v119, v119, v74
    v_add_f32 v117, v117, v55
    v_add_f32 v119, v119, v75
    v_rcp_f32 v117, v117
    v_rcp_f32 v119, v119
    v_mul_f32 v36, v117, v36
    v_mul_f32 v37, v117, v37
    v_mul_f32 v38, v117, v38
    v_mul_f32 v39, v117, v39
    v_cvt_pk_bf16_f32 v96, v36, v37
    v_mul_f32 v40, v117, v40
    v_mul_f32 v41, v117, v41
    v_cvt_pk_bf16_f32 v97, v38, v39
    v_mul_f32 v42, v117, v42
    v_mul_f32 v43, v117, v43
    v_cvt_pk_bf16_f32 v100, v40, v41
    v_mul_f32 v44, v117, v44
    v_mul_f32 v45, v117, v45
    v_cvt_pk_bf16_f32 v101, v42, v43
    v_mul_f32 v46, v117, v46
    v_mul_f32 v47, v117, v47
    v_cvt_pk_bf16_f32 v104, v44, v45
    v_mul_f32 v48, v117, v48
    v_mul_f32 v49, v117, v49
    v_cvt_pk_bf16_f32 v105, v46, v47
    v_mul_f32 v50, v117, v50
    v_mul_f32 v51, v117, v51
    v_cvt_pk_bf16_f32 v108, v48, v49
    v_mul_f32 v52, v117, v52
    v_mul_f32 v53, v117, v53
    v_cvt_pk_bf16_f32 v109, v50, v51
    v_mul_f32 v54, v117, v54
    v_mul_f32 v55, v117, v55
    v_cvt_pk_bf16_f32 v98, v52, v53
    v_mul_f32 v56, v119, v56
    v_mul_f32 v57, v119, v57
    v_cvt_pk_bf16_f32 v99, v54, v55
    v_mul_f32 v58, v119, v58
    v_mul_f32 v59, v119, v59
    v_cvt_pk_bf16_f32 v102, v56, v57
    v_mul_f32 v60, v119, v60
    v_mul_f32 v61, v119, v61
    v_cvt_pk_bf16_f32 v103, v58, v59
    v_mul_f32 v62, v119, v62
    v_mul_f32 v63, v119, v63
    v_cvt_pk_bf16_f32 v106, v60, v61
    v_mul_f32 v64, v119, v64
    v_mul_f32 v65, v119, v65
    v_cvt_pk_bf16_f32 v107, v62, v63
    v_mul_f32 v66, v119, v66
    v_mul_f32 v67, v119, v67
    v_cvt_pk_bf16_f32 v110, v64, v65
    v_mul_f32 v68, v119, v68
    v_mul_f32 v69, v119, v69
    v_cvt_pk_bf16_f32 v111, v66, v67
    v_mul_f32 v70, v119, v70
    v_mul_f32 v71, v119, v71
    v_cvt_pk_bf16_f32 v112, v68, v69
    v_mul_f32 v72, v119, v72
    v_mul_f32 v73, v119, v73
    v_cvt_pk_bf16_f32 v113, v70, v71
    v_mul_f32 v74, v119, v74
    v_mul_f32 v75, v119, v75
    v_cvt_pk_bf16_f32 v114, v72, v73
    v_cvt_pk_bf16_f32 v115, v74, v75
    ds_write_b128 v33, v[96:99] offset:0
    ds_write_b128 v33, v[100:103] offset:256
    ds_write_b128 v33, v[104:107] offset:512
    ds_write_b128 v33, v[108:111] offset:768
    ds_write_b64 v19, v[112:113] offset:1024
    ds_write_b64 v19, v[114:115] offset:1152
    v_add_u32 v33, s1, v7
    v_and_b32 v19, 31, v1
    v_lshl_add_u32 v19, v19, 3, s1
    ds_read_b128 v[200:203], v33 offset:0
    ds_read_b64 v[204:205], v19 offset:1024
    ds_read_b128 v[206:209], v33 offset:1280
    ds_read_b64 v[210:211], v19 offset:2304
    ds_read_b128 v[212:215], v33 offset:2560
    ds_read_b64 v[216:217], v19 offset:3584
    ds_read_b128 v[218:221], v33 offset:3840
    ds_read_b64 v[222:223], v19 offset:4864
    v_lshrrev_b32 v8, 2, v3
    v_lshl_add_u32 v8, v8, 3, v6
    v_min_u32 v224, 20, v8
    v_add_u32 v8, 4, v8
    v_min_u32 v225, 20, v8
    v_mul_u32_u24 v8, 21, v4
    v_add_u32 v8, 12800, v8
    v_add_lshl_u32 v224, v224, v8, 3
    v_add_lshl_u32 v225, v225, v8, 3
    v_add_lshl_u32 v226, v8, 20, 3
    v_mov_b32 v9, 0x100000
    v_cmp_gt_u32 vcc, 32, v1
    v_lshlrev_b32 v228, 3, v3
    s_nop 0
    v_cndmask_b32 v227, v9, v7, vcc
    v_cmp_eq_u32 vcc, 2, v4
    s_lshl_b32 s12, s9, 2
    s_add_u32 s12, s12, s70
    s_mul_i32 s12, s12, 81920
    v_cndmask_b32 v228, v9, v228, vcc
    s_add_u32 s60, s46, 7012352
    s_addc_u32 s61, s47, 0
    s_add_u32 s60, s60, s12
    s_addc_u32 s61, s61, 0
    s_mov_b32 s62, 81920
    s_mov_b32 s63, 0x20000
    s_cmp_eq_u32 s54, 0
    s_cbranch_scc1 m_kv_slow
    s_waitcnt vmcnt(0)
m_o_sum:
    .p2align 2
    v_pk_add_f32 v[36:37], v[132:133], v[164:165]
    v_pk_add_f32 v[38:39], v[134:135], v[166:167]
    v_pk_add_f32 v[40:41], v[136:137], v[168:169]
    v_pk_add_f32 v[42:43], v[138:139], v[170:171]
    v_pk_add_f32 v[44:45], v[140:141], v[172:173]
    v_pk_add_f32 v[46:47], v[142:143], v[174:175]
    v_pk_add_f32 v[48:49], v[144:145], v[176:177]
    v_pk_add_f32 v[50:51], v[146:147], v[178:179]
    v_pk_add_f32 v[52:53], v[148:149], v[180:181]
    v_pk_add_f32 v[54:55], v[150:151], v[182:183]
    v_pk_add_f32 v[56:57], v[152:153], v[184:185]
    v_pk_add_f32 v[58:59], v[154:155], v[186:187]
    v_pk_add_f32 v[60:61], v[156:157], v[188:189]
    v_pk_add_f32 v[62:63], v[158:159], v[190:191]
    v_pk_add_f32 v[64:65], v[160:161], v[192:193]
    v_pk_add_f32 v[66:67], v[162:163], v[194:195]
    v_pk_add_f32 v[36:37], v[36:37], v[52:53]
    v_pk_add_f32 v[38:39], v[38:39], v[54:55]
    v_pk_add_f32 v[40:41], v[40:41], v[56:57]
    v_pk_add_f32 v[42:43], v[42:43], v[58:59]
    v_pk_add_f32 v[44:45], v[44:45], v[60:61]
    v_pk_add_f32 v[46:47], v[46:47], v[62:63]
    v_pk_add_f32 v[48:49], v[48:49], v[64:65]
    v_pk_add_f32 v[50:51], v[50:51], v[66:67]
    v_pk_add_f32 v[36:37], v[36:37], v[44:45]
    v_pk_add_f32 v[38:39], v[38:39], v[46:47]
    v_pk_add_f32 v[40:41], v[40:41], v[48:49]
    v_pk_add_f32 v[42:43], v[42:43], v[50:51]
    v_pk_add_f32 v[36:37], v[36:37], v[40:41]
    v_pk_add_f32 v[38:39], v[38:39], v[42:43]
    v_cmp_u_f32 vcc, v36, v37
    v_cmp_u_f32 s[12:13], v38, v39
    s_nop 0
    s_or_b64 vcc, vcc, s[12:13]
    s_cbranch_vccnz m_kv_slow
m_o_ok:
    v_cvt_pk_bf16_f32 v40, v36, v37
    v_cvt_pk_bf16_f32 v41, v38, v39
    ds_write_b64 v10, v[40:41]
    v_mov_b32 v8, 163836
    s_waitcnt lgkmcnt(0)
    s_mov_b64 exec, 1
    ds_add_u32 v8, v12
    s_mov_b64 exec, -1
    s_mov_b32 s71, 4
    v_mov_b32 v254, 163836
m_dw53:
    ds_read_b32 v255, v254
    s_waitcnt lgkmcnt(0)
    v_readfirstlane_b32 s11, v255
    s_nop 0
    s_cmp_ge_u32 s11, s71
    s_cbranch_scc1 m_dd54
    s_branch m_dw53
m_dd54:
    s_mov_b32 s11, -1
    ds_read_b64 v[76:77], v224 offset:0
    ds_read_b64 v[78:79], v224 offset:672
    ds_read_b64 v[80:81], v224 offset:1344
    ds_read_b64 v[82:83], v225 offset:0
    ds_read_b64 v[84:85], v225 offset:672
    ds_read_b64 v[86:87], v225 offset:1344
    ds_read_b64 v[88:89], v226 offset:0
    ds_read_b64 v[90:91], v226 offset:672
    ds_read_b64 v[92:93], v226 offset:1344
    s_lshl_b32 s13, s8, 9
    s_lshl_b32 s14, s8, 7
    s_add_u32 s14, s14, 16384
    s_mov_b32 s15, 0x358637bd
    s_waitcnt vmcnt(15) lgkmcnt(7)
    v_mfma_f32_16x16x32_bf16 v[132:135], v[76:79], v[200:203], 0
    s_waitcnt vmcnt(14) lgkmcnt(4)
    v_mfma_f32_16x16x32_bf16 v[136:139], v[82:85], v[200:203], 0
    s_waitcnt vmcnt(13) lgkmcnt(1)
    v_mfma_f32_16x16x32_bf16 v[140:143], v[88:91], v[200:203], 0
    v_mfma_f32_16x16x16_bf16 v[132:135], v[80:81], v[204:205], v[132:135]
    v_mfma_f32_16x16x16_bf16 v[136:139], v[86:87], v[204:205], v[136:139]
    s_waitcnt lgkmcnt(0)
    v_mfma_f32_16x16x16_bf16 v[140:143], v[92:93], v[204:205], v[140:143]
    s_waitcnt vmcnt(12)
    v_mfma_f32_16x16x32_bf16 v[144:147], v[76:79], v[206:209], 0
    s_waitcnt vmcnt(11)
    v_mfma_f32_16x16x32_bf16 v[148:151], v[82:85], v[206:209], 0
    s_waitcnt vmcnt(10)
    v_mfma_f32_16x16x32_bf16 v[152:155], v[88:91], v[206:209], 0
    v_mfma_f32_16x16x16_bf16 v[144:147], v[80:81], v[210:211], v[144:147]
    v_mfma_f32_16x16x16_bf16 v[148:151], v[86:87], v[210:211], v[148:151]
    v_mfma_f32_16x16x16_bf16 v[152:155], v[92:93], v[210:211], v[152:155]
    s_waitcnt vmcnt(9)
    v_mfma_f32_16x16x32_bf16 v[156:159], v[76:79], v[212:215], 0
    s_waitcnt vmcnt(8)
    v_mfma_f32_16x16x32_bf16 v[160:163], v[82:85], v[212:215], 0
    s_waitcnt vmcnt(7)
    v_mfma_f32_16x16x32_bf16 v[164:167], v[88:91], v[212:215], 0
    v_mfma_f32_16x16x16_bf16 v[156:159], v[80:81], v[216:217], v[156:159]
    v_mfma_f32_16x16x16_bf16 v[160:163], v[86:87], v[216:217], v[160:163]
    v_mfma_f32_16x16x16_bf16 v[164:167], v[92:93], v[216:217], v[164:167]
    s_waitcnt vmcnt(6)
    v_mfma_f32_16x16x32_bf16 v[168:171], v[76:79], v[218:221], 0
    s_waitcnt vmcnt(5)
    v_mfma_f32_16x16x32_bf16 v[172:175], v[82:85], v[218:221], 0
    s_waitcnt vmcnt(4)
    v_mfma_f32_16x16x32_bf16 v[176:179], v[88:91], v[218:221], 0
    v_mfma_f32_16x16x16_bf16 v[168:171], v[80:81], v[222:223], v[168:171]
    v_mfma_f32_16x16x16_bf16 v[172:175], v[86:87], v[222:223], v[172:175]
    v_mfma_f32_16x16x16_bf16 v[176:179], v[92:93], v[222:223], v[176:179]
    v_add_f32 v140, s15, v140
    v_rcp_f32 v140, v140
    s_nop 0
    v_pk_mul_f32 v[132:133], v[132:133], v[140:141] op_sel:[0,0] op_sel_hi:[1,0]
    v_pk_mul_f32 v[134:135], v[134:135], v[140:141] op_sel:[0,0] op_sel_hi:[1,0]
    v_pk_mul_f32 v[136:137], v[136:137], v[140:141] op_sel:[0,0] op_sel_hi:[1,0]
    v_pk_mul_f32 v[138:139], v[138:139], v[140:141] op_sel:[0,0] op_sel_hi:[1,0]
    v_cvt_pk_bf16_f32 v96, v132, v133
    v_cvt_pk_bf16_f32 v97, v134, v135
    v_cvt_pk_bf16_f32 v98, v136, v137
    v_cvt_pk_bf16_f32 v99, v138, v139
    buffer_store_dwordx4 v[96:99], v227, s[60:63], s13 offen sc1
    buffer_store_dwordx2 v[96:97], v228, s[60:63], s14 offen sc1
    s_add_u32 s13, s13, 20480
    s_add_u32 s14, s14, 20480
    v_add_f32 v152, s15, v152
    v_rcp_f32 v152, v152
    s_nop 0
    v_pk_mul_f32 v[144:145], v[144:145], v[152:153] op_sel:[0,0] op_sel_hi:[1,0]
    v_pk_mul_f32 v[146:147], v[146:147], v[152:153] op_sel:[0,0] op_sel_hi:[1,0]
    v_pk_mul_f32 v[148:149], v[148:149], v[152:153] op_sel:[0,0] op_sel_hi:[1,0]
    v_pk_mul_f32 v[150:151], v[150:151], v[152:153] op_sel:[0,0] op_sel_hi:[1,0]
    v_cvt_pk_bf16_f32 v100, v144, v145
    v_cvt_pk_bf16_f32 v101, v146, v147
    v_cvt_pk_bf16_f32 v102, v148, v149
    v_cvt_pk_bf16_f32 v103, v150, v151
    buffer_store_dwordx4 v[100:103], v227, s[60:63], s13 offen sc1
    buffer_store_dwordx2 v[100:101], v228, s[60:63], s14 offen sc1
    s_add_u32 s13, s13, 20480
    s_add_u32 s14, s14, 20480
    v_add_f32 v164, s15, v164
    v_rcp_f32 v164, v164
    s_nop 0
    v_pk_mul_f32 v[156:157], v[156:157], v[164:165] op_sel:[0,0] op_sel_hi:[1,0]
    v_pk_mul_f32 v[158:159], v[158:159], v[164:165] op_sel:[0,0] op_sel_hi:[1,0]
    v_pk_mul_f32 v[160:161], v[160:161], v[164:165] op_sel:[0,0] op_sel_hi:[1,0]
    v_pk_mul_f32 v[162:163], v[162:163], v[164:165] op_sel:[0,0] op_sel_hi:[1,0]
    v_cvt_pk_bf16_f32 v104, v156, v157
    v_cvt_pk_bf16_f32 v105, v158, v159
    v_cvt_pk_bf16_f32 v106, v160, v161
    v_cvt_pk_bf16_f32 v107, v162, v163
    buffer_store_dwordx4 v[104:107], v227, s[60:63], s13 offen sc1
    buffer_store_dwordx2 v[104:105], v228, s[60:63], s14 offen sc1
    s_add_u32 s13, s13, 20480
    s_add_u32 s14, s14, 20480
    v_add_f32 v176, s15, v176
    v_rcp_f32 v176, v176
    s_nop 0
    v_pk_mul_f32 v[168:169], v[168:169], v[176:177] op_sel:[0,0] op_sel_hi:[1,0]
    v_pk_mul_f32 v[170:171], v[170:171], v[176:177] op_sel:[0,0] op_sel_hi:[1,0]
    v_pk_mul_f32 v[172:173], v[172:173], v[176:177] op_sel:[0,0] op_sel_hi:[1,0]
    v_pk_mul_f32 v[174:175], v[174:175], v[176:177] op_sel:[0,0] op_sel_hi:[1,0]
    v_cvt_pk_bf16_f32 v108, v168, v169
    v_cvt_pk_bf16_f32 v109, v170, v171
    v_cvt_pk_bf16_f32 v110, v172, v173
    v_cvt_pk_bf16_f32 v111, v174, v175
    buffer_store_dwordx4 v[108:111], v227, s[60:63], s13 offen sc1
    buffer_store_dwordx2 v[108:109], v228, s[60:63], s14 offen sc1
    s_add_u32 s13, s13, 20480
    s_add_u32 s14, s14, 20480
    s_setprio 0
    s_add_u32 s15, s70, 12
    s_xor_b32 s13, s15, s73
    s_mul_i32 s13, s13, 5120
    s_mul_i32 s15, s15, 5120
    s_add_u32 m0, s15, 0
    s_nop 0
    buffer_load_dwordx4 v7, s[48:51], s13 offen offset:0 sc1 lds
    buffer_load_dwordx4 v7, s[48:51], s13 offen offset:1024 sc1 lds
    buffer_load_dwordx4 v7, s[48:51], s13 offen offset:2048 sc1 lds
    buffer_load_dwordx4 v7, s[48:51], s13 offen offset:3072 sc1 lds
    s_add_u32 m0, s15, 4096
    s_add_u32 s13, s13, 4096
    buffer_load_dwordx4 v7, s[48:51], s13 offen sc1 lds
    s_add_u32 s15, s70, 16
    s_lshr_b32 s13, s73, 2
    s_and_b32 s13, s13, 2
    s_xor_b32 s13, s13, s15
    s_mul_i32 s13, s13, 5120
    s_mul_i32 s15, s15, 5120
    s_add_u32 m0, s15, 0
    s_nop 0
    buffer_load_dwordx4 v7, s[48:51], s13 offen offset:0 sc1 lds
    buffer_load_dwordx4 v7, s[48:51], s13 offen offset:1024 sc1 lds
    buffer_load_dwordx4 v7, s[48:51], s13 offen offset:2048 sc1 lds
    buffer_load_dwordx4 v7, s[48:51], s13 offen offset:3072 sc1 lds
    s_add_u32 m0, s15, 4096
    s_add_u32 s13, s13, 4096
    buffer_load_dwordx4 v7, s[48:51], s13 offen sc1 lds
m_cv2:
    s_mov_b32 s7, s10
    s_lshl_b32 s6, s4, 2
    s_and_b32 s12, s5, 3
    s_add_u32 s6, s6, s12
    s_lshl_b32 s10, s6, 2
    s_add_u32 s10, s10, s70
    s_mul_i32 s14, s3, 2816
    s_add_u32 s14, s14, 136192
    v_add_u32 v8, 0, v1
    v_mul_u32_u24 v16, 6554, v8
    v_lshrrev_b32 v16, 16, v16
    v_mul_u32_u24 v9, 10, v16
    v_sub_u32 v9, v8, v9
    v_lshlrev_b32 v9, 4, v9
    v_min_u32 v8, 15, v16
    v_mul_u32_u24 v19, 176, v8
    v_add3_u32 v19, v19, v9, s14
    v_mul_u32_u24 v16, 2560, v16
    v_add_u32 v16, v16, v9
    v_add_u32 v8, 64, v1
    v_mul_u32_u24 v17, 6554, v8
    v_lshrrev_b32 v17, 16, v17
    v_mul_u32_u24 v9, 10, v17
    v_sub_u32 v9, v8, v9
    v_lshlrev_b32 v9, 4, v9
    v_min_u32 v8, 15, v17
    v_mul_u32_u24 v20, 176, v8
    v_add3_u32 v20, v20, v9, s14
    v_mul_u32_u24 v17, 2560, v17
    v_add_u32 v17, v17, v9
    v_add_u32 v8, 128, v1
    v_mul_u32_u24 v18, 6554, v8
    v_lshrrev_b32 v18, 16, v18
    v_mul_u32_u24 v9, 10, v18
    v_sub_u32 v9, v8, v9
    v_lshlrev_b32 v9, 4, v9
    v_min_u32 v8, 15, v18
    v_mul_u32_u24 v21, 176, v8
    v_add3_u32 v21, v21, v9, s14
    v_mul_u32_u24 v18, 2560, v18
    v_add_u32 v18, v18, v9
    s_mul_i32 s12, s10, 40960
    s_mul_i32 s13, s7, 160
    s_add_u32 s12, s12, s13
    s_add_u32 s60, s42, s12
    s_addc_u32 s61, s43, 0
    s_mov_b32 s62, 39840
    s_mov_b32 s63, 0x20000
    v_mul_u32_u24 v22, 176, v3
    v_lshl_add_u32 v22, v4, 3, v22
    v_add_u32 v22, s14, v22
    s_mul_i32 s12, s70, 5120
    s_add_u32 s12, s12, 115712
    v_add_u32 v24, s12, v7
    v_lshl_add_u32 v23, v4, 2, v5
    v_lshlrev_b32 v23, 7, v23
    v_lshl_add_u32 v23, v6, 3, v23
    s_lshl_b32 s12, s70, 5
    s_add_u32 s12, s12, 104448
    v_add_u32 v23, s12, v23
    v_lshrrev_b32 v25, 3, v1
    v_lshlrev_b32 v25, 12, v25
    v_and_b32 v9, 7, v1
    v_lshl_add_u32 v25, v9, 4, v25
    s_waitcnt vmcnt(18)
    v_lshlrev_b32 v192, 8, v4
    v_lshl_add_u32 v192, v3, 3, v192
    s_mul_i32 s13, s69, 40960
    s_add_u32 s13, s13, 0
    v_add_u32 v26, s13, v7
    s_mul_i32 s13, s69, 10240
    s_add_u32 s13, s13, 81920
    v_add_u32 v27, s13, v7
    s_lshl_b32 s14, s69, 3
    s_xor_b32 s64, s73, s14
    s_lshr_b32 s15, s64, 3
    s_lshl_b32 s15, s15, 11
    s_add_u32 s15, s15, 16384
    s_lshl_b32 s64, s64, 10
    s_mov_b32 s73, 4000
    s_mul_i32 s12, s7, 327680
    s_lshl_b32 s13, s6, 7
    s_add_u32 s12, s12, s13
    s_mul_i32 s13, s10, 20480
    s_add_u32 s52, s46, 9633792
    s_addc_u32 s53, s47, 0
    s_add_u32 s52, s52, s12
    s_addc_u32 s53, s53, 0
    s_mov_b32 s54, 327680
    s_mov_b32 s55, 0x20000
    s_add_u32 s48, s46, 7012352
    s_addc_u32 s49, s47, 0
    s_add_u32 s48, s48, s13
    s_addc_u32 s49, s49, 0
    s_mov_b32 s50, 20480
    s_mov_b32 s51, 0x20000
    s_and_b32 s12, s65, s69
    s_cmp_lg_u32 s12, 0
    s_cbranch_scc1 m_x1
    s_waitcnt vmcnt(0)
m_x1:
    s_waitcnt vmcnt(2)
    s_barrier
m_gemm:
    s_xor_b32 s13, s64, 0
    buffer_load_dwordx4 v[28:31], v7, s[48:51], s13 offen offset:0 sc1
    s_xor_b32 s13, s64, 0
    buffer_load_dwordx4 v[32:35], v7, s[48:51], s13 offen offset:1024 sc1
    s_xor_b32 s13, s64, 2048
    buffer_load_dwordx4 v[36:39], v7, s[48:51], s13 offen offset:0 sc1
    s_xor_b32 s13, s64, 2048
    buffer_load_dwordx4 v[40:43], v7, s[48:51], s13 offen offset:1024 sc1
    s_xor_b32 s13, s64, 4096
    buffer_load_dwordx4 v[44:47], v7, s[48:51], s13 offen offset:0 sc1
    ds_read_b128 v[152:155], v26 offset:0
    ds_read_b128 v[156:159], v26 offset:1024
    ds_read_b128 v[160:163], v26 offset:2048
    ds_read_b128 v[164:167], v26 offset:3072
    ds_read_b128 v[168:171], v26 offset:4096
    ds_read_b128 v[172:175], v26 offset:5120
    ds_read_b128 v[176:179], v26 offset:6144
    ds_read_b128 v[180:183], v26 offset:7168
    ds_read_b128 v[184:187], v26 offset:8192
    ds_read_b128 v[188:191], v26 offset:9216
    ds_read_b128 v[68:71], v26 offset:10240
    ds_read_b128 v[72:75], v26 offset:11264
    ds_read_b128 v[76:79], v26 offset:12288
    ds_read_b128 v[80:83], v26 offset:13312
    ds_read_b128 v[84:87], v26 offset:14336
    ds_read_b128 v[88:91], v26 offset:15360
    ds_read_b128 v[92:95], v26 offset:16384
    ds_read_b128 v[96:99], v26 offset:17408
    ds_read_b128 v[100:103], v26 offset:18432
    ds_read_b128 v[104:107], v26 offset:19456
    ds_read_b128 v[108:111], v26 offset:20480
    ds_read_b128 v[112:115], v26 offset:21504
    ds_read_b128 v[116:119], v26 offset:22528
    ds_read_b128 v[120:123], v26 offset:23552
    ds_read_b128 v[124:127], v26 offset:24576
    ds_read_b128 v[128:131], v26 offset:25600
    ds_read_b128 v[200:203], v26 offset:26624
    ds_read_b128 v[204:207], v26 offset:27648
    s_waitcnt vmcnt(4)
    .p2align 2
m_gc0:
    v_max_u32 v8, v28, v30
    v_cmp_eq_u32 vcc, -1, v8
    s_nop 0
    s_cbranch_vccnz m_gs0
m_gd0:
    ds_read_b128 v[208:211], v26 offset:28672
    s_waitcnt lgkmcnt(14)
    v_mfma_f32_16x16x32_bf16 v[132:135], v[152:155], v[28:31], 0
    s_xor_b32 s13, s64, 4096
    buffer_load_dwordx4 v[48:51], v7, s[48:51], s13 offen offset:1024 sc1
    ds_read_b128 v[212:215], v26 offset:29696
    v_mfma_f32_16x16x32_bf16 v[136:139], v[156:159], v[28:31], 0
    ds_read_b128 v[152:155], v26 offset:30720
    v_mfma_f32_16x16x32_bf16 v[140:143], v[160:163], v[28:31], 0
    s_waitcnt vmcnt(4)
    .p2align 2
m_gc1:
    v_max_u32 v8, v32, v34
    v_cmp_eq_u32 vcc, -1, v8
    s_nop 0
    s_cbranch_vccnz m_gs1
m_gd1:
    ds_read_b128 v[156:159], v26 offset:31744
    v_mfma_f32_16x16x32_bf16 v[144:147], v[164:167], v[28:31], 0
    ds_read_b128 v[160:163], v26 offset:32768
    v_mfma_f32_16x16x32_bf16 v[148:151], v[168:171], v[28:31], 0
    ds_read_b128 v[164:167], v26 offset:33792
    v_mfma_f32_16x16x32_bf16 v[132:135], v[172:175], v[32:35], v[132:135]
    s_xor_b32 s13, s64, 6144
    buffer_load_dwordx4 v[52:55], v7, s[48:51], s13 offen offset:0 sc1
    ds_read_b128 v[168:171], v26 offset:34816
    v_mfma_f32_16x16x32_bf16 v[136:139], v[176:179], v[32:35], v[136:139]
    ds_read_b128 v[172:175], v26 offset:35840
    v_mfma_f32_16x16x32_bf16 v[140:143], v[180:183], v[32:35], v[140:143]
    s_waitcnt vmcnt(4)
    .p2align 2
m_gc2:
    v_max_u32 v8, v36, v38
    v_cmp_eq_u32 vcc, -1, v8
    s_nop 0
    s_cbranch_vccnz m_gs2
m_gd2:
    ds_read_b128 v[176:179], v26 offset:36864
    v_mfma_f32_16x16x32_bf16 v[144:147], v[184:187], v[32:35], v[144:147]
    ds_read_b128 v[180:183], v26 offset:37888
    v_mfma_f32_16x16x32_bf16 v[148:151], v[188:191], v[32:35], v[148:151]
    ds_read_b128 v[184:187], v26 offset:38912
    v_mfma_f32_16x16x32_bf16 v[132:135], v[68:71], v[36:39], v[132:135]
    s_xor_b32 s13, s64, 6144
    buffer_load_dwordx4 v[56:59], v7, s[48:51], s13 offen offset:1024 sc1
    ds_read_b128 v[188:191], v26 offset:39936
    v_mfma_f32_16x16x32_bf16 v[136:139], v[72:75], v[36:39], v[136:139]
    ds_read_b128 v[68:71], v27 offset:0
    v_mfma_f32_16x16x32_bf16 v[140:143], v[76:79], v[36:39], v[140:143]
    s_waitcnt vmcnt(4)
    .p2align 2
m_gc3:
    v_max_u32 v8, v40, v42
    v_cmp_eq_u32 vcc, -1, v8
    s_nop 0
    s_cbranch_vccnz m_gs3
m_gd3:
    ds_read_b128 v[72:75], v27 offset:1024
    v_mfma_f32_16x16x32_bf16 v[144:147], v[80:83], v[36:39], v[144:147]
    ds_read_b128 v[76:79], v27 offset:2048
    v_mfma_f32_16x16x32_bf16 v[148:151], v[84:87], v[36:39], v[148:151]
    ds_read_b128 v[80:83], v27 offset:3072
    s_waitcnt lgkmcnt(14)
    v_mfma_f32_16x16x32_bf16 v[132:135], v[88:91], v[40:43], v[132:135]
    buffer_load_dwordx2 v[60:61], v192, s[48:51], s15 offen offset:0 sc1
    buffer_load_dwordx2 v[62:63], v192, s[48:51], s15 offen offset:128 sc1
    ds_read_b128 v[84:87], v27 offset:4096
    v_mfma_f32_16x16x32_bf16 v[136:139], v[92:95], v[40:43], v[136:139]
    ds_read_b128 v[88:91], v27 offset:5120
    v_mfma_f32_16x16x32_bf16 v[140:143], v[96:99], v[40:43], v[140:143]
    s_waitcnt vmcnt(5)
    .p2align 2
m_gc4:
    v_max_u32 v8, v44, v46
    v_cmp_eq_u32 vcc, -1, v8
    s_nop 0
    s_cbranch_vccnz m_gs4
m_gd4:
    ds_read_b128 v[92:95], v27 offset:6144
    v_mfma_f32_16x16x32_bf16 v[144:147], v[100:103], v[40:43], v[144:147]
    ds_read_b128 v[96:99], v27 offset:7168
    v_mfma_f32_16x16x32_bf16 v[148:151], v[104:107], v[40:43], v[148:151]
    ds_read_b128 v[100:103], v27 offset:8192
    v_mfma_f32_16x16x32_bf16 v[132:135], v[108:111], v[44:47], v[132:135]
    buffer_load_dwordx2 v[64:65], v192, s[48:51], s15 offen offset:1024 sc1
    buffer_load_dwordx2 v[66:67], v192, s[48:51], s15 offen offset:1152 sc1
    ds_read_b128 v[104:107], v27 offset:9216
    v_mfma_f32_16x16x32_bf16 v[136:139], v[112:115], v[44:47], v[136:139]
    v_mfma_f32_16x16x32_bf16 v[140:143], v[116:119], v[44:47], v[140:143]
    s_waitcnt vmcnt(6)
    .p2align 2
m_gc5:
    v_max_u32 v8, v48, v50
    v_cmp_eq_u32 vcc, -1, v8
    s_nop 0
    s_cbranch_vccnz m_gs5
m_gd5:
    v_mfma_f32_16x16x32_bf16 v[144:147], v[120:123], v[44:47], v[144:147]
    v_mfma_f32_16x16x32_bf16 v[148:151], v[124:127], v[44:47], v[148:151]
    v_mfma_f32_16x16x32_bf16 v[132:135], v[128:131], v[48:51], v[132:135]
    v_mfma_f32_16x16x32_bf16 v[136:139], v[200:203], v[48:51], v[136:139]
    v_mfma_f32_16x16x32_bf16 v[140:143], v[204:207], v[48:51], v[140:143]
    s_waitcnt vmcnt(5)
    .p2align 2
m_gc6:
    v_max_u32 v8, v52, v54
    v_cmp_eq_u32 vcc, -1, v8
    s_nop 0
    s_cbranch_vccnz m_gs6
m_gd6:
    v_mfma_f32_16x16x32_bf16 v[144:147], v[208:211], v[48:51], v[144:147]
    v_mfma_f32_16x16x32_bf16 v[148:151], v[212:215], v[48:51], v[148:151]
    s_waitcnt lgkmcnt(14)
    v_mfma_f32_16x16x32_bf16 v[132:135], v[152:155], v[52:55], v[132:135]
    v_mfma_f32_16x16x32_bf16 v[136:139], v[156:159], v[52:55], v[136:139]
    v_mfma_f32_16x16x32_bf16 v[140:143], v[160:163], v[52:55], v[140:143]
    s_waitcnt vmcnt(4)
    .p2align 2
m_gc7:
    v_max_u32 v8, v56, v58
    v_cmp_eq_u32 vcc, -1, v8
    s_nop 0
    s_cbranch_vccnz m_gs7
m_gd7:
    v_mfma_f32_16x16x32_bf16 v[144:147], v[164:167], v[52:55], v[144:147]
    v_mfma_f32_16x16x32_bf16 v[148:151], v[168:171], v[52:55], v[148:151]
    v_mfma_f32_16x16x32_bf16 v[132:135], v[172:175], v[56:59], v[132:135]
    s_waitcnt lgkmcnt(13)
    v_mfma_f32_16x16x32_bf16 v[136:139], v[176:179], v[56:59], v[136:139]
    s_waitcnt lgkmcnt(12)
    v_mfma_f32_16x16x32_bf16 v[140:143], v[180:183], v[56:59], v[140:143]
    s_waitcnt vmcnt(2)
    .p2align 2
m_gc8:
    v_max_u32 v8, v60, v62
    v_cmp_eq_u32 vcc, -1, v8
    s_nop 0
    s_cbranch_vccnz m_gs8
m_gd8:
    s_waitcnt lgkmcnt(11)
    v_mfma_f32_16x16x32_bf16 v[144:147], v[184:187], v[56:59], v[144:147]
    s_waitcnt lgkmcnt(10)
    v_mfma_f32_16x16x32_bf16 v[148:151], v[188:191], v[56:59], v[148:151]
    s_waitcnt lgkmcnt(9)
    v_mfma_f32_16x16x32_bf16 v[132:135], v[68:71], v[60:63], v[132:135]
    s_waitcnt lgkmcnt(8)
    v_mfma_f32_16x16x32_bf16 v[136:139], v[72:75], v[60:63], v[136:139]
    s_waitcnt lgkmcnt(7)
    v_mfma_f32_16x16x32_bf16 v[140:143], v[76:79], v[60:63], v[140:143]
    s_waitcnt vmcnt(0)
    .p2align 2
m_gc9:
    v_max_u32 v8, v64, v66
    v_cmp_eq_u32 vcc, -1, v8
    s_nop 0
    s_cbranch_vccnz m_gs9
m_gd9:
    s_waitcnt lgkmcnt(6)
    v_mfma_f32_16x16x32_bf16 v[144:147], v[80:83], v[60:63], v[144:147]
    s_waitcnt lgkmcnt(5)
    v_mfma_f32_16x16x32_bf16 v[148:151], v[84:87], v[60:63], v[148:151]
    s_waitcnt lgkmcnt(4)
    v_mfma_f32_16x16x32_bf16 v[132:135], v[88:91], v[64:67], v[132:135]
    s_waitcnt lgkmcnt(3)
    v_mfma_f32_16x16x32_bf16 v[136:139], v[92:95], v[64:67], v[136:139]
    s_cmp_lg_u32 s69, 0
    s_cbranch_scc1 m_gemm0
    s_add_u32 s12, s70, 0
    s_min_u32 s12, s12, 9
    s_lshl_b32 s13, s12, 15
    s_lshl_b32 s12, s12, 10
    s_add_u32 m0, s12, 104448
    s_nop 0
    buffer_load_dwordx4 v25, s[52:55], s13 offen sc1 lds
    s_add_u32 s12, s70, 4
    s_min_u32 s12, s12, 9
    s_lshl_b32 s13, s12, 15
    s_lshl_b32 s12, s12, 10
    s_add_u32 m0, s12, 104448
    s_nop 0
    buffer_load_dwordx4 v25, s[52:55], s13 offen sc1 lds
    s_add_u32 s12, s70, 8
    s_min_u32 s12, s12, 9
    s_lshl_b32 s13, s12, 15
    s_lshl_b32 s12, s12, 10
    s_add_u32 m0, s12, 104448
    s_nop 0
    buffer_load_dwordx4 v25, s[52:55], s13 offen sc1 lds
m_gemm0:
    s_waitcnt lgkmcnt(2)
    v_mfma_f32_16x16x32_bf16 v[140:143], v[96:99], v[64:67], v[140:143]
    s_waitcnt lgkmcnt(1)
    v_mfma_f32_16x16x32_bf16 v[144:147], v[100:103], v[64:67], v[144:147]
    s_waitcnt lgkmcnt(0)
    v_mfma_f32_16x16x32_bf16 v[148:151], v[104:107], v[64:67], v[148:151]
    v_cmp_u_f32 vcc, v132, v132
    s_nop 0
    s_cbranch_vccnz m_g_bad
m_g_ok:
    s_cmp_eq_u32 s69, 0
    s_cbranch_scc1 m_t_lo
    s_mov_b32 s71, 8
    v_mov_b32 v254, 163836
m_dw55:
    ds_read_b32 v255, v254
    s_waitcnt lgkmcnt(0)
    v_readfirstlane_b32 s11, v255
    s_nop 0
    s_cmp_ge_u32 s11, s71
    s_cbranch_scc1 m_dd56
    s_sleep 1
    s_branch m_dw55
m_dd56:
    s_mov_b32 s11, -1
    ds_read_b128 v[152:155], v24 offset:0
    ds_read_b128 v[156:159], v24 offset:1024
    ds_read_b128 v[160:163], v24 offset:2048
    ds_read_b128 v[164:167], v24 offset:3072
    ds_read_b128 v[168:171], v24 offset:4096
    s_waitcnt lgkmcnt(4)
    v_pk_add_f32 v[132:133], v[132:133], v[152:153]
    v_cvt_pk_bf16_f32 v172, v132, v133
    v_pk_add_f32 v[134:135], v[134:135], v[154:155]
    v_cvt_pk_bf16_f32 v173, v134, v135
    ds_write_b64 v22, v[172:173] offset:0
    s_waitcnt lgkmcnt(4)
    v_pk_add_f32 v[136:137], v[136:137], v[156:157]
    v_cvt_pk_bf16_f32 v174, v136, v137
    v_pk_add_f32 v[138:139], v[138:139], v[158:159]
    v_cvt_pk_bf16_f32 v175, v138, v139
    ds_write_b64 v22, v[174:175] offset:32
    s_waitcnt lgkmcnt(4)
    v_pk_add_f32 v[140:141], v[140:141], v[160:161]
    v_cvt_pk_bf16_f32 v176, v140, v141
    v_pk_add_f32 v[142:143], v[142:143], v[162:163]
    v_cvt_pk_bf16_f32 v177, v142, v143
    ds_write_b64 v22, v[176:177] offset:64
    s_waitcnt lgkmcnt(4)
    v_pk_add_f32 v[144:145], v[144:145], v[164:165]
    v_cvt_pk_bf16_f32 v178, v144, v145
    v_pk_add_f32 v[146:147], v[146:147], v[166:167]
    v_cvt_pk_bf16_f32 v179, v146, v147
    ds_write_b64 v22, v[178:179] offset:96
    s_waitcnt lgkmcnt(4)
    v_pk_add_f32 v[148:149], v[148:149], v[168:169]
    v_cvt_pk_bf16_f32 v180, v148, v149
    v_pk_add_f32 v[150:151], v[150:151], v[170:171]
    v_cvt_pk_bf16_f32 v181, v150, v151
    ds_write_b64 v22, v[180:181] offset:128
    ds_read_b128 v[28:31], v19
    ds_read_b128 v[32:35], v20
    ds_read_b128 v[36:39], v21
    s_waitcnt lgkmcnt(2)
    buffer_store_dwordx4 v[28:31], v16, s[60:63], 0 offen nt
    s_waitcnt lgkmcnt(1)
    buffer_store_dwordx4 v[32:35], v17, s[60:63], 0 offen nt
    s_waitcnt lgkmcnt(0)
    buffer_store_dwordx4 v[36:39], v18, s[60:63], 0 offen nt
    s_branch m_end
m_t_lo:
    ds_write_b128 v24, v[132:135] offset:0
    ds_write_b128 v24, v[136:139] offset:1024
    ds_write_b128 v24, v[140:143] offset:2048
    ds_write_b128 v24, v[144:147] offset:3072
    ds_write_b128 v24, v[148:151] offset:4096
    v_mov_b32 v8, 163836
    s_waitcnt lgkmcnt(0)
    s_mov_b64 exec, 1
    ds_add_u32 v8, v12
    s_mov_b64 exec, -1
    s_waitcnt vmcnt(0)
    v_mov_b32 v8, 163808
    s_waitcnt lgkmcnt(0)
    s_mov_b64 exec, 1
    ds_add_u32 v8, v12
    s_mov_b64 exec, -1
    s_mov_b32 s71, 4
    v_mov_b32 v254, 163808
m_dw57:
    ds_read_b32 v255, v254
    s_waitcnt lgkmcnt(0)
    v_readfirstlane_b32 s11, v255
    s_nop 0
    s_cmp_ge_u32 s11, s71
    s_cbranch_scc1 m_dd58
    s_sleep 1
    s_branch m_dw57
m_dd58:
    s_mov_b32 s11, -1
m_ytr:
    ds_read_b64_tr_b16 v[152:153], v23 offset:0
    ds_read_b64_tr_b16 v[154:155], v23 offset:2048
    ds_read_b64_tr_b16 v[156:157], v23 offset:4096
    ds_read_b64_tr_b16 v[158:159], v23 offset:6144
    ds_read_b64_tr_b16 v[160:161], v23 offset:8192
    s_waitcnt lgkmcnt(4)
    ds_write_b64 v22, v[152:153] offset:0
    s_waitcnt lgkmcnt(4)
    ds_write_b64 v22, v[154:155] offset:32
    s_waitcnt lgkmcnt(4)
    ds_write_b64 v22, v[156:157] offset:64
    s_waitcnt lgkmcnt(4)
    ds_write_b64 v22, v[158:159] offset:96
    s_waitcnt lgkmcnt(4)
    ds_write_b64 v22, v[160:161] offset:128
    ds_read_b128 v[28:31], v19
    ds_read_b128 v[32:35], v20
    ds_read_b128 v[36:39], v21
    v_pk_max_u16 v8, v152, v153
    v_pk_max_u16 v9, v154, v155
    v_pk_max_u16 v8, v8, v156
    v_pk_max_u16 v9, v9, v157
    v_pk_max_u16 v8, v8, v158
    v_pk_max_u16 v9, v9, v159
    v_pk_max_u16 v8, v8, v160
    v_pk_max_u16 v9, v9, v161
    v_pk_max_u16 v8, v8, v9
    v_lshlrev_b32 v9, 16, v8
    v_max_u32 v8, v8, v9
    v_cmp_le_u32 vcc, 0xffff0000, v8
    s_nop 0
    s_cbranch_vccnz m_y_bad
m_y_ok:
    s_waitcnt lgkmcnt(2)
    buffer_store_dwordx4 v[28:31], v16, s[60:63], 0 offen offset:1280 nt
    s_waitcnt lgkmcnt(1)
    buffer_store_dwordx4 v[32:35], v17, s[60:63], 0 offen offset:1280 nt
    s_waitcnt lgkmcnt(0)
    buffer_store_dwordx4 v[36:39], v18, s[60:63], 0 offen offset:1280 nt
m_end:
    s_endpgm
m_kv_slow:
    s_sub_u32 s72, s72, 1
    s_cmp_le_i32 s72, 0
    s_cbranch_scc1 m_o_ok
    s_cmp_eq_u32 s54, 0
    s_cbranch_scc1 m_kv_all
    s_cmp_lt_u32 s72, 3996
    s_cbranch_scc1 m_kv_all
    s_waitcnt vmcnt(15)
    v_cmp_u_f32 vcc, v132, v133
    v_cmp_u_f32 s[12:13], v134, v135
    s_nop 0
    s_or_b64 vcc, vcc, s[12:13]
    s_cbranch_vccz m_kr59
    s_xor_b32 s13, s0, 0
    s_mul_i32 s13, s13, 3456
    buffer_load_dwordx4 v[132:135], v16, s[52:55], s13 offen sc1
m_kr59:
    s_waitcnt vmcnt(14)
    v_cmp_u_f32 vcc, v136, v137
    v_cmp_u_f32 s[12:13], v138, v139
    s_nop 0
    s_or_b64 vcc, vcc, s[12:13]
    s_cbranch_vccz m_kr60
    s_xor_b32 s13, s0, 1
    s_mul_i32 s13, s13, 3456
    buffer_load_dwordx4 v[136:139], v16, s[52:55], s13 offen sc1
m_kr60:
    s_waitcnt vmcnt(13)
    v_cmp_u_f32 vcc, v140, v141
    v_cmp_u_f32 s[12:13], v142, v143
    s_nop 0
    s_or_b64 vcc, vcc, s[12:13]
    s_cbranch_vccz m_kr61
    s_xor_b32 s13, s0, 2
    s_mul_i32 s13, s13, 3456
    buffer_load_dwordx4 v[140:143], v16, s[52:55], s13 offen sc1
m_kr61:
    s_waitcnt vmcnt(12)
    v_cmp_u_f32 vcc, v144, v145
    v_cmp_u_f32 s[12:13], v146, v147
    s_nop 0
    s_or_b64 vcc, vcc, s[12:13]
    s_cbranch_vccz m_kr62
    s_xor_b32 s13, s0, 3
    s_mul_i32 s13, s13, 3456
    buffer_load_dwordx4 v[144:147], v16, s[52:55], s13 offen sc1
m_kr62:
    s_waitcnt vmcnt(11)
    v_cmp_u_f32 vcc, v148, v149
    v_cmp_u_f32 s[12:13], v150, v151
    s_nop 0
    s_or_b64 vcc, vcc, s[12:13]
    s_cbranch_vccz m_kr63
    s_xor_b32 s13, s0, 4
    s_mul_i32 s13, s13, 3456
    buffer_load_dwordx4 v[148:151], v16, s[52:55], s13 offen sc1
m_kr63:
    s_waitcnt vmcnt(10)
    v_cmp_u_f32 vcc, v152, v153
    v_cmp_u_f32 s[12:13], v154, v155
    s_nop 0
    s_or_b64 vcc, vcc, s[12:13]
    s_cbranch_vccz m_kr64
    s_xor_b32 s13, s0, 5
    s_mul_i32 s13, s13, 3456
    buffer_load_dwordx4 v[152:155], v16, s[52:55], s13 offen sc1
m_kr64:
    s_waitcnt vmcnt(9)
    v_cmp_u_f32 vcc, v156, v157
    v_cmp_u_f32 s[12:13], v158, v159
    s_nop 0
    s_or_b64 vcc, vcc, s[12:13]
    s_cbranch_vccz m_kr65
    s_xor_b32 s13, s0, 6
    s_mul_i32 s13, s13, 3456
    buffer_load_dwordx4 v[156:159], v16, s[52:55], s13 offen sc1
m_kr65:
    s_waitcnt vmcnt(8)
    v_cmp_u_f32 vcc, v160, v161
    v_cmp_u_f32 s[12:13], v162, v163
    s_nop 0
    s_or_b64 vcc, vcc, s[12:13]
    s_cbranch_vccz m_kr66
    s_xor_b32 s13, s0, 7
    s_mul_i32 s13, s13, 3456
    buffer_load_dwordx4 v[160:163], v16, s[52:55], s13 offen sc1
m_kr66:
    s_waitcnt vmcnt(7)
    v_cmp_u_f32 vcc, v164, v165
    v_cmp_u_f32 s[12:13], v166, v167
    s_nop 0
    s_or_b64 vcc, vcc, s[12:13]
    s_cbranch_vccz m_kr67
    s_xor_b32 s13, s0, 8
    s_mul_i32 s13, s13, 3456
    buffer_load_dwordx4 v[164:167], v16, s[52:55], s13 offen sc1
m_kr67:
    s_waitcnt vmcnt(6)
    v_cmp_u_f32 vcc, v168, v169
    v_cmp_u_f32 s[12:13], v170, v171
    s_nop 0
    s_or_b64 vcc, vcc, s[12:13]
    s_cbranch_vccz m_kr68
    s_xor_b32 s13, s0, 9
    s_mul_i32 s13, s13, 3456
    buffer_load_dwordx4 v[168:171], v16, s[52:55], s13 offen sc1
m_kr68:
    s_waitcnt vmcnt(5)
    v_cmp_u_f32 vcc, v172, v173
    v_cmp_u_f32 s[12:13], v174, v175
    s_nop 0
    s_or_b64 vcc, vcc, s[12:13]
    s_cbranch_vccz m_kr69
    s_xor_b32 s13, s0, 10
    s_mul_i32 s13, s13, 3456
    buffer_load_dwordx4 v[172:175], v16, s[52:55], s13 offen sc1
m_kr69:
    s_waitcnt vmcnt(4)
    v_cmp_u_f32 vcc, v176, v177
    v_cmp_u_f32 s[12:13], v178, v179
    s_nop 0
    s_or_b64 vcc, vcc, s[12:13]
    s_cbranch_vccz m_kr70
    s_xor_b32 s13, s0, 11
    s_mul_i32 s13, s13, 3456
    buffer_load_dwordx4 v[176:179], v16, s[52:55], s13 offen sc1
m_kr70:
    s_waitcnt vmcnt(3)
    v_cmp_u_f32 vcc, v180, v181
    v_cmp_u_f32 s[12:13], v182, v183
    s_nop 0
    s_or_b64 vcc, vcc, s[12:13]
    s_cbranch_vccz m_kr71
    s_xor_b32 s13, s0, 12
    s_mul_i32 s13, s13, 3456
    buffer_load_dwordx4 v[180:183], v16, s[52:55], s13 offen sc1
m_kr71:
    s_waitcnt vmcnt(2)
    v_cmp_u_f32 vcc, v184, v185
    v_cmp_u_f32 s[12:13], v186, v187
    s_nop 0
    s_or_b64 vcc, vcc, s[12:13]
    s_cbranch_vccz m_kr72
    s_xor_b32 s13, s0, 13
    s_mul_i32 s13, s13, 3456
    buffer_load_dwordx4 v[184:187], v16, s[52:55], s13 offen sc1
m_kr72:
    s_waitcnt vmcnt(1)
    v_cmp_u_f32 vcc, v188, v189
    v_cmp_u_f32 s[12:13], v190, v191
    s_nop 0
    s_or_b64 vcc, vcc, s[12:13]
    s_cbranch_vccz m_kr73
    s_xor_b32 s13, s0, 14
    s_mul_i32 s13, s13, 3456
    buffer_load_dwordx4 v[188:191], v16, s[52:55], s13 offen sc1
m_kr73:
    s_waitcnt vmcnt(0)
    v_cmp_u_f32 vcc, v192, v193
    v_cmp_u_f32 s[12:13], v194, v195
    s_nop 0
    s_or_b64 vcc, vcc, s[12:13]
    s_cbranch_vccz m_kr74
    s_xor_b32 s13, s0, 15
    s_mul_i32 s13, s13, 3456
    buffer_load_dwordx4 v[192:195], v16, s[52:55], s13 offen sc1
m_kr74:
    s_waitcnt vmcnt(0)
    s_branch m_o_sum
m_kv_all:
    s_cmp_eq_u32 s54, 0
    s_cselect_b32 s12, 0, 16384
    s_mov_b32 s54, 55296
    v_subrev_u32 v14, s12, v253
    v_cmp_le_u32 vcc, 32, v1
    s_nop 1
    v_cndmask_b32 v14, v14, v253, vcc
    s_mov_b32 s71, 40000
m_poll75:
    buffer_load_dword v15, v14, s[56:59], 0 offen sc1
    s_waitcnt vmcnt(0)
    v_cmp_ne_u32 vcc, 0, v15
    s_nop 0
    s_cmp_eq_u64 vcc, -1
    s_cbranch_scc1 m_pd76
    s_sleep 8
    s_sub_u32 s71, s71, 1
    s_cmp_lg_u32 s71, 0
    s_cbranch_scc1 m_poll75
m_pd76:
    s_xor_b32 s13, s0, 0
    s_mul_i32 s13, s13, 3456
    buffer_load_dwordx4 v[132:135], v16, s[52:55], s13 offen sc1
    s_xor_b32 s13, s0, 1
    s_mul_i32 s13, s13, 3456
    buffer_load_dwordx4 v[136:139], v16, s[52:55], s13 offen sc1
    s_xor_b32 s13, s0, 2
    s_mul_i32 s13, s13, 3456
    buffer_load_dwordx4 v[140:143], v16, s[52:55], s13 offen sc1
    s_xor_b32 s13, s0, 3
    s_mul_i32 s13, s13, 3456
    buffer_load_dwordx4 v[144:147], v16, s[52:55], s13 offen sc1
    s_xor_b32 s13, s0, 4
    s_mul_i32 s13, s13, 3456
    buffer_load_dwordx4 v[148:151], v16, s[52:55], s13 offen sc1
    s_xor_b32 s13, s0, 5
    s_mul_i32 s13, s13, 3456
    buffer_load_dwordx4 v[152:155], v16, s[52:55], s13 offen sc1
    s_xor_b32 s13, s0, 6
    s_mul_i32 s13, s13, 3456
    buffer_load_dwordx4 v[156:159], v16, s[52:55], s13 offen sc1
    s_xor_b32 s13, s0, 7
    s_mul_i32 s13, s13, 3456
    buffer_load_dwordx4 v[160:163], v16, s[52:55], s13 offen sc1
    s_xor_b32 s13, s0, 8
    s_mul_i32 s13, s13, 3456
    buffer_load_dwordx4 v[164:167], v16, s[52:55], s13 offen sc1
    s_xor_b32 s13, s0, 9
    s_mul_i32 s13, s13, 3456
    buffer_load_dwordx4 v[168:171], v16, s[52:55], s13 offen sc1
    s_xor_b32 s13, s0, 10
    s_mul_i32 s13, s13, 3456
    buffer_load_dwordx4 v[172:175], v16, s[52:55], s13 offen sc1
    s_xor_b32 s13, s0, 11
    s_mul_i32 s13, s13, 3456
    buffer_load_dwordx4 v[176:179], v16, s[52:55], s13 offen sc1
    s_xor_b32 s13, s0, 12
    s_mul_i32 s13, s13, 3456
    buffer_load_dwordx4 v[180:183], v16, s[52:55], s13 offen sc1
    s_xor_b32 s13, s0, 13
    s_mul_i32 s13, s13, 3456
    buffer_load_dwordx4 v[184:187], v16, s[52:55], s13 offen sc1
    s_xor_b32 s13, s0, 14
    s_mul_i32 s13, s13, 3456
    buffer_load_dwordx4 v[188:191], v16, s[52:55], s13 offen sc1
    s_xor_b32 s13, s0, 15
    s_mul_i32 s13, s13, 3456
    buffer_load_dwordx4 v[192:195], v16, s[52:55], s13 offen sc1
    s_waitcnt vmcnt(0)
    s_branch m_o_sum
m_y_bad:
    s_sub_u32 s73, s73, 1
    s_cmp_le_i32 s73, 0
    s_cbranch_scc1 m_y_ok
    s_mov_b32 s13, 0
    s_mov_b32 m0, 104448
    s_nop 0
    buffer_load_dwordx4 v25, s[52:55], s13 offen sc1 lds
    s_add_u32 s13, s13, 32768
    s_mov_b32 m0, 105472
    s_nop 0
    buffer_load_dwordx4 v25, s[52:55], s13 offen sc1 lds
    s_add_u32 s13, s13, 32768
    s_mov_b32 m0, 106496
    s_nop 0
    buffer_load_dwordx4 v25, s[52:55], s13 offen sc1 lds
    s_add_u32 s13, s13, 32768
    s_mov_b32 m0, 107520
    s_nop 0
    buffer_load_dwordx4 v25, s[52:55], s13 offen sc1 lds
    s_add_u32 s13, s13, 32768
    s_mov_b32 m0, 108544
    s_nop 0
    buffer_load_dwordx4 v25, s[52:55], s13 offen sc1 lds
    s_add_u32 s13, s13, 32768
    s_mov_b32 m0, 109568
    s_nop 0
    buffer_load_dwordx4 v25, s[52:55], s13 offen sc1 lds
    s_add_u32 s13, s13, 32768
    s_mov_b32 m0, 110592
    s_nop 0
    buffer_load_dwordx4 v25, s[52:55], s13 offen sc1 lds
    s_add_u32 s13, s13, 32768
    s_mov_b32 m0, 111616
    s_nop 0
    buffer_load_dwordx4 v25, s[52:55], s13 offen sc1 lds
    s_add_u32 s13, s13, 32768
    s_mov_b32 m0, 112640
    s_nop 0
    buffer_load_dwordx4 v25, s[52:55], s13 offen sc1 lds
    s_add_u32 s13, s13, 32768
    s_mov_b32 m0, 113664
    s_nop 0
    buffer_load_dwordx4 v25, s[52:55], s13 offen sc1 lds
    s_add_u32 s13, s13, 32768
    s_waitcnt vmcnt(0)
    s_branch m_ytr
m_g_bad:
    s_sub_u32 s73, s73, 200
    s_cmp_le_i32 s73, 0
    s_cbranch_scc1 m_g_ok
    s_branch m_gemm
m_gs0:
    s_sub_u32 s73, s73, 1
    s_cmp_le_i32 s73, 0
    s_cbranch_scc1 m_gd0
    s_waitcnt vmcnt(0)
    s_xor_b32 s13, s64, 0
    buffer_load_dwordx4 v[28:31], v7, s[48:51], s13 offen offset:0 sc1
m_gr77:
    v_max_u32 v8, v32, v34
    v_cmp_eq_u32 vcc, -1, v8
    s_nop 0
    s_cbranch_vccz m_gr78
    s_xor_b32 s13, s64, 0
    buffer_load_dwordx4 v[32:35], v7, s[48:51], s13 offen offset:1024 sc1
m_gr78:
    v_max_u32 v8, v36, v38
    v_cmp_eq_u32 vcc, -1, v8
    s_nop 0
    s_cbranch_vccz m_gr79
    s_xor_b32 s13, s64, 2048
    buffer_load_dwordx4 v[36:39], v7, s[48:51], s13 offen offset:0 sc1
m_gr79:
    v_max_u32 v8, v40, v42
    v_cmp_eq_u32 vcc, -1, v8
    s_nop 0
    s_cbranch_vccz m_gr80
    s_xor_b32 s13, s64, 2048
    buffer_load_dwordx4 v[40:43], v7, s[48:51], s13 offen offset:1024 sc1
m_gr80:
    v_max_u32 v8, v44, v46
    v_cmp_eq_u32 vcc, -1, v8
    s_nop 0
    s_cbranch_vccz m_gr81
    s_xor_b32 s13, s64, 4096
    buffer_load_dwordx4 v[44:47], v7, s[48:51], s13 offen offset:0 sc1
m_gr81:
    s_waitcnt vmcnt(0)
    s_branch m_gc0
m_gs1:
    s_sub_u32 s73, s73, 1
    s_cmp_le_i32 s73, 0
    s_cbranch_scc1 m_gd1
    s_waitcnt vmcnt(0)
    s_xor_b32 s13, s64, 0
    buffer_load_dwordx4 v[32:35], v7, s[48:51], s13 offen offset:1024 sc1
m_gr82:
    v_max_u32 v8, v36, v38
    v_cmp_eq_u32 vcc, -1, v8
    s_nop 0
    s_cbranch_vccz m_gr83
    s_xor_b32 s13, s64, 2048
    buffer_load_dwordx4 v[36:39], v7, s[48:51], s13 offen offset:0 sc1
m_gr83:
    v_max_u32 v8, v40, v42
    v_cmp_eq_u32 vcc, -1, v8
    s_nop 0
    s_cbranch_vccz m_gr84
    s_xor_b32 s13, s64, 2048
    buffer_load_dwordx4 v[40:43], v7, s[48:51], s13 offen offset:1024 sc1
m_gr84:
    v_max_u32 v8, v44, v46
    v_cmp_eq_u32 vcc, -1, v8
    s_nop 0
    s_cbranch_vccz m_gr85
    s_xor_b32 s13, s64, 4096
    buffer_load_dwordx4 v[44:47], v7, s[48:51], s13 offen offset:0 sc1
m_gr85:
    v_max_u32 v8, v48, v50
    v_cmp_eq_u32 vcc, -1, v8
    s_nop 0
    s_cbranch_vccz m_gr86
    s_xor_b32 s13, s64, 4096
    buffer_load_dwordx4 v[48:51], v7, s[48:51], s13 offen offset:1024 sc1
m_gr86:
    s_waitcnt vmcnt(0)
    s_branch m_gc1
m_gs2:
    s_sub_u32 s73, s73, 1
    s_cmp_le_i32 s73, 0
    s_cbranch_scc1 m_gd2
    s_waitcnt vmcnt(0)
    s_xor_b32 s13, s64, 2048
    buffer_load_dwordx4 v[36:39], v7, s[48:51], s13 offen offset:0 sc1
m_gr87:
    v_max_u32 v8, v40, v42
    v_cmp_eq_u32 vcc, -1, v8
    s_nop 0
    s_cbranch_vccz m_gr88
    s_xor_b32 s13, s64, 2048
    buffer_load_dwordx4 v[40:43], v7, s[48:51], s13 offen offset:1024 sc1
m_gr88:
    v_max_u32 v8, v44, v46
    v_cmp_eq_u32 vcc, -1, v8
    s_nop 0
    s_cbranch_vccz m_gr89
    s_xor_b32 s13, s64, 4096
    buffer_load_dwordx4 v[44:47], v7, s[48:51], s13 offen offset:0 sc1
m_gr89:
    v_max_u32 v8, v48, v50
    v_cmp_eq_u32 vcc, -1, v8
    s_nop 0
    s_cbranch_vccz m_gr90
    s_xor_b32 s13, s64, 4096
    buffer_load_dwordx4 v[48:51], v7, s[48:51], s13 offen offset:1024 sc1
m_gr90:
    v_max_u32 v8, v52, v54
    v_cmp_eq_u32 vcc, -1, v8
    s_nop 0
    s_cbranch_vccz m_gr91
    s_xor_b32 s13, s64, 6144
    buffer_load_dwordx4 v[52:55], v7, s[48:51], s13 offen offset:0 sc1
m_gr91:
    s_waitcnt vmcnt(0)
    s_branch m_gc2
m_gs3:
    s_sub_u32 s73, s73, 1
    s_cmp_le_i32 s73, 0
    s_cbranch_scc1 m_gd3
    s_waitcnt vmcnt(0)
    s_xor_b32 s13, s64, 2048
    buffer_load_dwordx4 v[40:43], v7, s[48:51], s13 offen offset:1024 sc1
m_gr92:
    v_max_u32 v8, v44, v46
    v_cmp_eq_u32 vcc, -1, v8
    s_nop 0
    s_cbranch_vccz m_gr93
    s_xor_b32 s13, s64, 4096
    buffer_load_dwordx4 v[44:47], v7, s[48:51], s13 offen offset:0 sc1
m_gr93:
    v_max_u32 v8, v48, v50
    v_cmp_eq_u32 vcc, -1, v8
    s_nop 0
    s_cbranch_vccz m_gr94
    s_xor_b32 s13, s64, 4096
    buffer_load_dwordx4 v[48:51], v7, s[48:51], s13 offen offset:1024 sc1
m_gr94:
    v_max_u32 v8, v52, v54
    v_cmp_eq_u32 vcc, -1, v8
    s_nop 0
    s_cbranch_vccz m_gr95
    s_xor_b32 s13, s64, 6144
    buffer_load_dwordx4 v[52:55], v7, s[48:51], s13 offen offset:0 sc1
m_gr95:
    v_max_u32 v8, v56, v58
    v_cmp_eq_u32 vcc, -1, v8
    s_nop 0
    s_cbranch_vccz m_gr96
    s_xor_b32 s13, s64, 6144
    buffer_load_dwordx4 v[56:59], v7, s[48:51], s13 offen offset:1024 sc1
m_gr96:
    s_waitcnt vmcnt(0)
    s_branch m_gc3
m_gs4:
    s_sub_u32 s73, s73, 1
    s_cmp_le_i32 s73, 0
    s_cbranch_scc1 m_gd4
    s_waitcnt vmcnt(0)
    s_xor_b32 s13, s64, 4096
    buffer_load_dwordx4 v[44:47], v7, s[48:51], s13 offen offset:0 sc1
m_gr97:
    v_max_u32 v8, v48, v50
    v_cmp_eq_u32 vcc, -1, v8
    s_nop 0
    s_cbranch_vccz m_gr98
    s_xor_b32 s13, s64, 4096
    buffer_load_dwordx4 v[48:51], v7, s[48:51], s13 offen offset:1024 sc1
m_gr98:
    v_max_u32 v8, v52, v54
    v_cmp_eq_u32 vcc, -1, v8
    s_nop 0
    s_cbranch_vccz m_gr99
    s_xor_b32 s13, s64, 6144
    buffer_load_dwordx4 v[52:55], v7, s[48:51], s13 offen offset:0 sc1
m_gr99:
    v_max_u32 v8, v56, v58
    v_cmp_eq_u32 vcc, -1, v8
    s_nop 0
    s_cbranch_vccz m_gr100
    s_xor_b32 s13, s64, 6144
    buffer_load_dwordx4 v[56:59], v7, s[48:51], s13 offen offset:1024 sc1
m_gr100:
    v_max_u32 v8, v60, v62
    v_cmp_eq_u32 vcc, -1, v8
    s_nop 0
    s_cbranch_vccz m_gr101
    buffer_load_dwordx2 v[60:61], v192, s[48:51], s15 offen offset:0 sc1
    buffer_load_dwordx2 v[62:63], v192, s[48:51], s15 offen offset:128 sc1
m_gr101:
    s_waitcnt vmcnt(0)
    s_branch m_gc4
m_gs5:
    s_sub_u32 s73, s73, 1
    s_cmp_le_i32 s73, 0
    s_cbranch_scc1 m_gd5
    s_waitcnt vmcnt(0)
    s_xor_b32 s13, s64, 4096
    buffer_load_dwordx4 v[48:51], v7, s[48:51], s13 offen offset:1024 sc1
m_gr102:
    v_max_u32 v8, v52, v54
    v_cmp_eq_u32 vcc, -1, v8
    s_nop 0
    s_cbranch_vccz m_gr103
    s_xor_b32 s13, s64, 6144
    buffer_load_dwordx4 v[52:55], v7, s[48:51], s13 offen offset:0 sc1
m_gr103:
    v_max_u32 v8, v56, v58
    v_cmp_eq_u32 vcc, -1, v8
    s_nop 0
    s_cbranch_vccz m_gr104
    s_xor_b32 s13, s64, 6144
    buffer_load_dwordx4 v[56:59], v7, s[48:51], s13 offen offset:1024 sc1
m_gr104:
    v_max_u32 v8, v60, v62
    v_cmp_eq_u32 vcc, -1, v8
    s_nop 0
    s_cbranch_vccz m_gr105
    buffer_load_dwordx2 v[60:61], v192, s[48:51], s15 offen offset:0 sc1
    buffer_load_dwordx2 v[62:63], v192, s[48:51], s15 offen offset:128 sc1
m_gr105:
    v_max_u32 v8, v64, v66
    v_cmp_eq_u32 vcc, -1, v8
    s_nop 0
    s_cbranch_vccz m_gr106
    buffer_load_dwordx2 v[64:65], v192, s[48:51], s15 offen offset:1024 sc1
    buffer_load_dwordx2 v[66:67], v192, s[48:51], s15 offen offset:1152 sc1
m_gr106:
    s_waitcnt vmcnt(0)
    s_branch m_gc5
m_gs6:
    s_sub_u32 s73, s73, 1
    s_cmp_le_i32 s73, 0
    s_cbranch_scc1 m_gd6
    s_waitcnt vmcnt(0)
    s_xor_b32 s13, s64, 6144
    buffer_load_dwordx4 v[52:55], v7, s[48:51], s13 offen offset:0 sc1
m_gr107:
    v_max_u32 v8, v56, v58
    v_cmp_eq_u32 vcc, -1, v8
    s_nop 0
    s_cbranch_vccz m_gr108
    s_xor_b32 s13, s64, 6144
    buffer_load_dwordx4 v[56:59], v7, s[48:51], s13 offen offset:1024 sc1
m_gr108:
    v_max_u32 v8, v60, v62
    v_cmp_eq_u32 vcc, -1, v8
    s_nop 0
    s_cbranch_vccz m_gr109
    buffer_load_dwordx2 v[60:61], v192, s[48:51], s15 offen offset:0 sc1
    buffer_load_dwordx2 v[62:63], v192, s[48:51], s15 offen offset:128 sc1
m_gr109:
    v_max_u32 v8, v64, v66
    v_cmp_eq_u32 vcc, -1, v8
    s_nop 0
    s_cbranch_vccz m_gr110
    buffer_load_dwordx2 v[64:65], v192, s[48:51], s15 offen offset:1024 sc1
    buffer_load_dwordx2 v[66:67], v192, s[48:51], s15 offen offset:1152 sc1
m_gr110:
    s_waitcnt vmcnt(0)
    s_branch m_gc6
m_gs7:
    s_sub_u32 s73, s73, 1
    s_cmp_le_i32 s73, 0
    s_cbranch_scc1 m_gd7
    s_waitcnt vmcnt(0)
    s_xor_b32 s13, s64, 6144
    buffer_load_dwordx4 v[56:59], v7, s[48:51], s13 offen offset:1024 sc1
m_gr111:
    v_max_u32 v8, v60, v62
    v_cmp_eq_u32 vcc, -1, v8
    s_nop 0
    s_cbranch_vccz m_gr112
    buffer_load_dwordx2 v[60:61], v192, s[48:51], s15 offen offset:0 sc1
    buffer_load_dwordx2 v[62:63], v192, s[48:51], s15 offen offset:128 sc1
m_gr112:
    v_max_u32 v8, v64, v66
    v_cmp_eq_u32 vcc, -1, v8
    s_nop 0
    s_cbranch_vccz m_gr113
    buffer_load_dwordx2 v[64:65], v192, s[48:51], s15 offen offset:1024 sc1
    buffer_load_dwordx2 v[66:67], v192, s[48:51], s15 offen offset:1152 sc1
m_gr113:
    s_waitcnt vmcnt(0)
    s_branch m_gc7
m_gs8:
    s_sub_u32 s73, s73, 1
    s_cmp_le_i32 s73, 0
    s_cbranch_scc1 m_gd8
    s_waitcnt vmcnt(0)
    buffer_load_dwordx2 v[60:61], v192, s[48:51], s15 offen offset:0 sc1
    buffer_load_dwordx2 v[62:63], v192, s[48:51], s15 offen offset:128 sc1
m_gr114:
    v_max_u32 v8, v64, v66
    v_cmp_eq_u32 vcc, -1, v8
    s_nop 0
    s_cbranch_vccz m_gr115
    buffer_load_dwordx2 v[64:65], v192, s[48:51], s15 offen offset:1024 sc1
    buffer_load_dwordx2 v[66:67], v192, s[48:51], s15 offen offset:1152 sc1
m_gr115:
    s_waitcnt vmcnt(0)
    s_branch m_gc8
m_gs9:
    s_sub_u32 s73, s73, 1
    s_cmp_le_i32 s73, 0
    s_cbranch_scc1 m_gd9
    s_waitcnt vmcnt(0)
    buffer_load_dwordx2 v[64:65], v192, s[48:51], s15 offen offset:1024 sc1
    buffer_load_dwordx2 v[66:67], v192, s[48:51], s15 offen offset:1152 sc1
m_gr116:
    s_waitcnt vmcnt(0)
    s_branch m_gc9
m_exit:
    s_endpgm
m_codeend:
.section .rodata,"a"
.p2align 6
.amdhsa_kernel concat_heads__linear_kernel_hedgehog__ssm_conv_s4__prompt_kernel
  .amdhsa_next_free_vgpr 256
  .amdhsa_next_free_sgpr 75
  .amdhsa_accum_offset 256
  .amdhsa_group_segment_fixed_size 0
  .amdhsa_kernarg_size 128
  .amdhsa_user_sgpr_count 2
  .amdhsa_user_sgpr_kernarg_segment_ptr 1
  .amdhsa_system_sgpr_workgroup_id_x 1
.end_amdhsa_kernel
```
